```python
import torch

def _softmax(x, axis=-1):
    return torch.softmax(x, dim=axis)
def _gelu(x):
    return torch.nn.functional.gelu(x, approximate="tanh")
def _silu(x):
    return torch.nn.functional.silu(x)
def _sigmoid(x):
    return torch.sigmoid(x)
def _layernorm(x, axis=-1, eps=1e-5):
    m = x.mean(dim=axis, keepdim=True)
    v = x.var(dim=axis, keepdim=True, unbiased=False)
    return (x - m) / torch.sqrt(v + eps)
def _scatter_add(tgt, idx, src, axis=0):
    return tgt.clone().index_add_(axis, idx, src)
def _segment_sum(src, seg, n):
    out = torch.zeros((n,) + src.shape[1:], dtype=src.dtype)
    return out.index_add_(0, seg, src)
def _pad(x, pw):
    flat = tuple(v for pair in reversed(pw) for v in pair)
    return torch.nn.functional.pad(x, flat)

kernel_name = 'sequential_preLN__ssm_conv_s4__swiglu_ffn__prompt'

def setup_inputs():

    _w = (lambda a: (lambda t: t.to(torch.bfloat16) if t.is_floating_point() else t)(torch.as_tensor(a)))
    def _A_setup():
        B, L, D, N = 1, 2048, 448, 256
        A_re = -(lambda _x: torch.exp(torch.as_tensor(_x)))((lambda *s: torch.randn(*s, dtype=torch.bfloat16) * 3.2)(D, N))
        A_im = torch.pi * (lambda *s: torch.randn(*s, dtype=torch.bfloat16) * 0.05)(D, N)
        B_re = (lambda *s: torch.randn(*s, dtype=torch.bfloat16) * 0.05)(D, N)
        B_im = (lambda *s: torch.randn(*s, dtype=torch.bfloat16) * 0.05)(D, N)
        C_re = (lambda *s: torch.randn(*s, dtype=torch.bfloat16) * 0.05)(D, N)
        C_im = (lambda *s: torch.randn(*s, dtype=torch.bfloat16) * 0.05)(D, N)
        log_dt = (lambda *s: torch.randn(*s, dtype=torch.bfloat16) * 0.05)(D) * 0.5 - 4.0
        Dskip = (lambda *s: torch.randn(*s, dtype=torch.bfloat16) * 0.05)(D)
        return {
            "u": _w((lambda *s: torch.randn(*s, dtype=torch.bfloat16) * 0.05)(B, L, D)),
            "A_re": _w(A_re),
            "A_im": _w(A_im),
            "B_re": _w(B_re),
            "B_im": _w(B_im),
            "C_re": _w(C_re),
            "C_im": _w(C_im),
            "log_dt": _w(log_dt),
            "Dskip": _w(Dskip),
        }
    _A_in = _A_setup()

    def _B_setup():
        B, S, D, F = 1, 2048, 448, 1792
        return {
            "x": _w((lambda *s: torch.randn(*s, dtype=torch.bfloat16) * 0.05)(B, S, D)),
            "w_gate": _w((lambda *s: torch.randn(*s, dtype=torch.bfloat16) * 0.05)(D, F)),
            "w_up": _w((lambda *s: torch.randn(*s, dtype=torch.bfloat16) * 0.05)(D, F)),
            "w_down": _w((lambda *s: torch.randn(*s, dtype=torch.bfloat16) * 0.05)(F, D)),
        }
    _B_in = _B_setup()

    return {
        "A_u": _A_in["u"],
        "A_A_re": _A_in["A_re"],
        "A_A_im": _A_in["A_im"],
        "A_B_re": _A_in["B_re"],
        "A_B_im": _A_in["B_im"],
        "A_C_re": _A_in["C_re"],
        "A_C_im": _A_in["C_im"],
        "A_log_dt": _A_in["log_dt"],
        "A_Dskip": _A_in["Dskip"],
        "B_x": _B_in["x"],
        "B_w_gate": _B_in["w_gate"],
        "B_w_up": _B_in["w_up"],
        "B_w_down": _B_in["w_down"],
    }

def reference(A_u, A_A_re, A_A_im, A_B_re, A_B_im, A_C_re, A_C_im, A_log_dt, A_Dskip, B_x, B_w_gate, B_w_up, B_w_down):
    def _A_ref(u, A_re, A_im, B_re, B_im, C_re, C_im, log_dt, Dskip):
        Bsz, L, D = u.shape
        dt = torch.exp(log_dt)[:, None]
        A = A_re + 1j * A_im
        Bc = B_re + 1j * B_im
        Cc = C_re + 1j * C_im
        logdA = dt * A
        dB = dt * Bc
        l = (lambda x, dt: x.to(dt))(torch.arange(L), A_re.dtype)
        P = torch.exp(logdA[:, :, None] * l[None, None, :])
        K = torch.einsum("dn,dnl,dn->dl", Cc, P, dB).real
        L2 = 2 * L
        Kp = _pad(K, ((0, 0), (0, L)))
        up = (lambda x, *d: x.permute(*d))(u, 0, 2, 1)
        up = _pad(up, ((0, 0), (0, 0), (0, L)))
        Kf = (lambda x, axes=(-2,-1): torch.fft.rfft2(x.float(), dim=axes))(Kp[:, None, :], axes=(-2, -1))
        Uf = (lambda x, axes=(-2,-1): torch.fft.rfft2(x.float(), dim=axes))(up[:, :, None, :], axes=(-2, -1))
        Yf = Uf * Kf[None, :, :, :]
        y = (lambda x, s, axes=(-2,-1): torch.fft.irfft2(x, s=s, dim=axes).to(torch.bfloat16))(Yf, (1, L2), axes=(-2, -1))[:, :, 0, :L]
        y = (lambda x, *d: x.permute(*d))(y, 0, 2, 1) + u * Dskip[None, None, :]
        return y

    def _B_ref(x, w_gate, w_up, w_down):
        g = _silu(x @ w_gate)
        u = x @ w_up
        return (g * u) @ w_down

    x = A_u
    h = x + _A_ref(_layernorm(x, axis=-1), A_A_re, A_A_im, A_B_re, A_B_im, A_C_re, A_C_im, A_log_dt, A_Dskip)
    h2 = h + _B_ref(_layernorm(h, axis=-1), B_w_gate, B_w_up, B_w_down)
    return h2
```

```asm
; @launch grid=(224,1,1) block=(256,1,1) lds=163840
.amdgcn_target "amdgcn-amd-amdhsa--gfx950"
.text
.globl sequential_preLN__ssm_conv_s4__swiglu_ffn__prompt_kernel
.p2align 8
.type sequential_preLN__ssm_conv_s4__swiglu_ffn__prompt_kernel,@function
sequential_preLN__ssm_conv_s4__swiglu_ffn__prompt_kernel:
    s_cmp_ge_u32 s2, 224
    s_cbranch_scc1 K_END
    s_load_dwordx16 s[8:23], s[0:1], 0
    s_load_dwordx16 s[24:39], s[0:1], 64
    v_and_b32 v1, 63, v0
    v_lshrrev_b32 v2, 6, v0
    s_nop 0
    v_readfirstlane_b32 s3, v2
    s_and_b32 s6, s2, 7
    s_lshr_b32 s7, s2, 3
    s_mul_i32 s44, s7, 37
    s_lshr_b32 s44, s44, 8
    s_mul_i32 s45, s44, 7
    s_sub_u32 s45, s7, s45
    s_lshr_b32 s46, s6, 1
    s_lshl_b32 s46, s46, 2
    s_add_u32 s4, s46, s44
    s_and_b32 s46, s6, 1
    s_mul_i32 s46, s46, 7
    s_add_u32 s5, s46, s45
    s_waitcnt lgkmcnt(0)
    s_mov_b32 s40, s38
    s_and_b32 s41, s39, 0xffff
    s_mov_b32 s42, 0xc00000
    s_mov_b32 s43, 0x20000
    v_lshrrev_b32 v2, 6, v0
    v_lshrrev_b32 v3, 7, v0
    s_lshl_b32 s6, s2, 1
    s_mov_b32 s44, s8
    s_and_b32 s45, s9, 0xffff
    s_mov_b32 s46, 0x1c0000
    s_mov_b32 s47, 0x20000
    s_getpc_b64 s[92:93]
K_PC:
    s_sub_u32 s92, s92, K_PC-sequential_preLN__ssm_conv_s4__swiglu_ffn__prompt_kernel
    s_subb_u32 s93, s93, 0
    s_lshr_b32 s52, s2, 3
    s_mul_i32 s53, s52, 13108
    s_lshr_b32 s53, s53, 16
    s_mul_i32 s53, s53, 5
    s_sub_u32 s52, s52, s53
    s_lshl_b32 s52, s52, 13
    s_lshl_b32 s53, s3, 11
    s_add_u32 s52, s52, s53
    v_and_b32 v246, 15, v1
    v_lshl_add_u32 v246, v246, 7, s52
    s_mov_b32 s53, K_CODE_END-sequential_preLN__ssm_conv_s4__swiglu_ffn__prompt_kernel-4
    v_min_u32 v246, s53, v246
    global_load_dword v247, v246, s[92:93]
    s_lshl_b32 s93, s2, 4
    s_lshl_b32 s52, s3, 2
    s_add_u32 s93, s93, s52
    v_lshrrev_b32 v52, 4, v1
    v_add_u32 v52, s93, v52
    v_mul_u32_u24 v52, 896, v52
    v_and_b32 v53, 15, v1
    v_mul_u32_u24 v53, 56, v53
    v_add_u32 v52, v52, v53
    buffer_load_dwordx4 v[28:31], v52, s[44:47], 0 offen offset:0
    buffer_load_dwordx4 v[32:35], v52, s[44:47], 0 offen offset:16
    buffer_load_dwordx4 v[36:39], v52, s[44:47], 0 offen offset:32
    buffer_load_dwordx2 v[40:41], v52, s[44:47], 0 offen offset:48
    s_mul_i32 s90, s2, 9363
    s_lshr_b32 s90, s90, 16
    s_mul_i32 s91, s90, 7
    s_sub_u32 s91, s2, s91
    v_lshrrev_b32 v54, 3, v0
    v_and_b32 v55, 7, v0
    s_lshl_b32 s53, s90, 6
    v_add_u32 v56, s53, v54
    v_mul_u32_u24 v56, 896, v56
    v_lshl_add_u32 v56, v55, 4, v56
    s_lshl_b32 s53, s91, 7
    v_add_u32 v56, s53, v56
    buffer_load_dwordx4 v[44:47], v56, s[44:47], 0 offen
    s_mov_b32 s53, 28672
    buffer_load_dwordx4 v[48:51], v56, s[44:47], s53 offen
    v_add_u32 v4, s6, v3
    v_lshlrev_b32 v4, 9, v4
    v_and_b32 v5, 127, v0
    v_lshl_add_u32 v4, v5, 1, v4
    global_load_ushort v16, v4, s[10:11]
    global_load_ushort v17, v4, s[10:11] offset:256
    global_load_ushort v18, v4, s[12:13]
    global_load_ushort v19, v4, s[12:13] offset:256
    global_load_ushort v20, v4, s[14:15]
    global_load_ushort v21, v4, s[14:15] offset:256
    global_load_ushort v22, v4, s[16:17]
    global_load_ushort v23, v4, s[16:17] offset:256
    global_load_ushort v24, v4, s[18:19]
    global_load_ushort v25, v4, s[18:19] offset:256
    global_load_ushort v26, v4, s[20:21]
    global_load_ushort v27, v4, s[20:21] offset:256
    s_lshl_b32 s92, s2, 2
    s_load_dword s96, s[22:23], s92
    s_load_dword s97, s[24:25], s92
    v_lshlrev_b32 v9, 3, v0
    v_sub_u32 v9, 2047, v9
    v_subrev_u32 v10, 0, v9
    v_cvt_f32_i32 v11, v10
    v_cvt_pk_bf16_f32 v11, v11, v11
    v_and_b32 v11, 0xffff, v11
    v_subrev_u32 v11, 17024, v11
    v_cmp_gt_i32 vcc, 128, v10
    s_nop 1
    v_cndmask_b32 v11, v11, v10, vcc
    v_cmp_gt_i32 vcc, 0, v10
    v_mov_b32 v12, 768
    s_nop 0
    v_cndmask_b32 v11, v11, v12, vcc
    v_lshrrev_b32 v12, 5, v11
    v_add_lshl_u32 v11, v11, v12, 2
    v_add_u32 v224, 120384, v11
    v_subrev_u32 v10, 1, v9
    v_cvt_f32_i32 v11, v10
    v_cvt_pk_bf16_f32 v11, v11, v11
    v_and_b32 v11, 0xffff, v11
    v_subrev_u32 v11, 17024, v11
    v_cmp_gt_i32 vcc, 128, v10
    s_nop 1
    v_cndmask_b32 v11, v11, v10, vcc
    v_cmp_gt_i32 vcc, 0, v10
    v_mov_b32 v12, 768
    s_nop 0
    v_cndmask_b32 v11, v11, v12, vcc
    v_lshrrev_b32 v12, 5, v11
    v_add_lshl_u32 v11, v11, v12, 2
    v_add_u32 v225, 120384, v11
    v_subrev_u32 v10, 2, v9
    v_cvt_f32_i32 v11, v10
    v_cvt_pk_bf16_f32 v11, v11, v11
    v_and_b32 v11, 0xffff, v11
    v_subrev_u32 v11, 17024, v11
    v_cmp_gt_i32 vcc, 128, v10
    s_nop 1
    v_cndmask_b32 v11, v11, v10, vcc
    v_cmp_gt_i32 vcc, 0, v10
    v_mov_b32 v12, 768
    s_nop 0
    v_cndmask_b32 v11, v11, v12, vcc
    v_lshrrev_b32 v12, 5, v11
    v_add_lshl_u32 v11, v11, v12, 2
    v_add_u32 v226, 120384, v11
    v_subrev_u32 v10, 3, v9
    v_cvt_f32_i32 v11, v10
    v_cvt_pk_bf16_f32 v11, v11, v11
    v_and_b32 v11, 0xffff, v11
    v_subrev_u32 v11, 17024, v11
    v_cmp_gt_i32 vcc, 128, v10
    s_nop 1
    v_cndmask_b32 v11, v11, v10, vcc
    v_cmp_gt_i32 vcc, 0, v10
    v_mov_b32 v12, 768
    s_nop 0
    v_cndmask_b32 v11, v11, v12, vcc
    v_lshrrev_b32 v12, 5, v11
    v_add_lshl_u32 v11, v11, v12, 2
    v_add_u32 v227, 120384, v11
    v_subrev_u32 v10, 4, v9
    v_cvt_f32_i32 v11, v10
    v_cvt_pk_bf16_f32 v11, v11, v11
    v_and_b32 v11, 0xffff, v11
    v_subrev_u32 v11, 17024, v11
    v_cmp_gt_i32 vcc, 128, v10
    s_nop 1
    v_cndmask_b32 v11, v11, v10, vcc
    v_cmp_gt_i32 vcc, 0, v10
    v_mov_b32 v12, 768
    s_nop 0
    v_cndmask_b32 v11, v11, v12, vcc
    v_lshrrev_b32 v12, 5, v11
    v_add_lshl_u32 v11, v11, v12, 2
    v_add_u32 v228, 120384, v11
    v_subrev_u32 v10, 5, v9
    v_cvt_f32_i32 v11, v10
    v_cvt_pk_bf16_f32 v11, v11, v11
    v_and_b32 v11, 0xffff, v11
    v_subrev_u32 v11, 17024, v11
    v_cmp_gt_i32 vcc, 128, v10
    s_nop 1
    v_cndmask_b32 v11, v11, v10, vcc
    v_cmp_gt_i32 vcc, 0, v10
    v_mov_b32 v12, 768
    s_nop 0
    v_cndmask_b32 v11, v11, v12, vcc
    v_lshrrev_b32 v12, 5, v11
    v_add_lshl_u32 v11, v11, v12, 2
    v_add_u32 v229, 120384, v11
    v_subrev_u32 v10, 6, v9
    v_cvt_f32_i32 v11, v10
    v_cvt_pk_bf16_f32 v11, v11, v11
    v_and_b32 v11, 0xffff, v11
    v_subrev_u32 v11, 17024, v11
    v_cmp_gt_i32 vcc, 128, v10
    s_nop 1
    v_cndmask_b32 v11, v11, v10, vcc
    v_cmp_gt_i32 vcc, 0, v10
    v_mov_b32 v12, 768
    s_nop 0
    v_cndmask_b32 v11, v11, v12, vcc
    v_lshrrev_b32 v12, 5, v11
    v_add_lshl_u32 v11, v11, v12, 2
    v_add_u32 v230, 120384, v11
    v_subrev_u32 v10, 7, v9
    v_cvt_f32_i32 v11, v10
    v_cvt_pk_bf16_f32 v11, v11, v11
    v_and_b32 v11, 0xffff, v11
    v_subrev_u32 v11, 17024, v11
    v_cmp_gt_i32 vcc, 128, v10
    s_nop 1
    v_cndmask_b32 v11, v11, v10, vcc
    v_cmp_gt_i32 vcc, 0, v10
    v_mov_b32 v12, 768
    s_nop 0
    v_cndmask_b32 v11, v11, v12, vcc
    v_lshrrev_b32 v12, 5, v11
    v_add_lshl_u32 v11, v11, v12, 2
    v_add_u32 v231, 120384, v11
    v_subrev_u32 v10, 8, v9
    v_cvt_f32_i32 v11, v10
    v_cvt_pk_bf16_f32 v11, v11, v11
    v_and_b32 v11, 0xffff, v11
    v_subrev_u32 v11, 17024, v11
    v_cmp_gt_i32 vcc, 128, v10
    s_nop 1
    v_cndmask_b32 v11, v11, v10, vcc
    v_cmp_gt_i32 vcc, 0, v10
    v_mov_b32 v12, 768
    s_nop 0
    v_cndmask_b32 v11, v11, v12, vcc
    v_lshrrev_b32 v12, 5, v11
    v_add_lshl_u32 v11, v11, v12, 2
    v_add_u32 v232, 120384, v11
    v_subrev_u32 v10, 9, v9
    v_cvt_f32_i32 v11, v10
    v_cvt_pk_bf16_f32 v11, v11, v11
    v_and_b32 v11, 0xffff, v11
    v_subrev_u32 v11, 17024, v11
    v_cmp_gt_i32 vcc, 128, v10
    s_nop 1
    v_cndmask_b32 v11, v11, v10, vcc
    v_cmp_gt_i32 vcc, 0, v10
    v_mov_b32 v12, 768
    s_nop 0
    v_cndmask_b32 v11, v11, v12, vcc
    v_lshrrev_b32 v12, 5, v11
    v_add_lshl_u32 v11, v11, v12, 2
    v_add_u32 v233, 120384, v11
    v_subrev_u32 v10, 10, v9
    v_cvt_f32_i32 v11, v10
    v_cvt_pk_bf16_f32 v11, v11, v11
    v_and_b32 v11, 0xffff, v11
    v_subrev_u32 v11, 17024, v11
    v_cmp_gt_i32 vcc, 128, v10
    s_nop 1
    v_cndmask_b32 v11, v11, v10, vcc
    v_cmp_gt_i32 vcc, 0, v10
    v_mov_b32 v12, 768
    s_nop 0
    v_cndmask_b32 v11, v11, v12, vcc
    v_lshrrev_b32 v12, 5, v11
    v_add_lshl_u32 v11, v11, v12, 2
    v_add_u32 v234, 120384, v11
    v_and_b32 v10, 15, v1
    v_lshrrev_b32 v11, 4, v1
    v_lshlrev_b32 v11, 2, v11
    v_lshrrev_b32 v12, 3, v10
    v_lshlrev_b32 v12, 7, v12
    v_and_b32 v13, 7, v10
    v_add_u32 v12, v12, v13
    v_lshlrev_b32 v13, 4, v10
    v_add_u32 v13, 512, v13
    s_and_b32 s7, s3, 1
    s_cmp_eq_u32 s7, 0
    s_cselect_b64 s[50:51], -1, 0
    v_cndmask_b32 v12, v13, v12, s[50:51]
    v_mov_b32 v13, 1
    v_mov_b32 v14, 8
    v_cndmask_b32 v244, v13, v14, s[50:51]
    v_mad_u32_u24 v12, v244, v11, v12
    v_lshrrev_b32 v13, 2, v10
    v_lshlrev_b32 v13, 6, v13
    v_and_b32 v14, 3, v10
    v_add3_u32 v13, v13, v14, 0
    v_add_u32 v13, 256, v13
    v_lshrrev_b32 v14, 1, v10
    v_lshlrev_b32 v14, 5, v14
    v_and_b32 v15, 1, v10
    v_add_u32 v14, v14, v15
    v_add_u32 v14, 256, v14
    v_cmp_gt_u32 vcc, 8, v10
    s_nop 1
    v_cndmask_b32 v13, v14, v13, vcc
    v_mov_b32 v14, 2
    v_mov_b32 v15, 4
    v_cndmask_b32 v245, v14, v15, vcc
    v_mad_u32_u24 v13, v245, v11, v13
    v_mul_u32_u24 v14, 3200, v3
    v_add_u32 v14, 120384, v14
    v_lshrrev_b32 v15, 5, v12
    v_add_u32 v15, v15, v12
    v_lshl_add_u32 v236, v15, 2, v14
    v_add_u32 v12, v12, v244
    v_lshrrev_b32 v15, 5, v12
    v_add_u32 v15, v15, v12
    v_lshl_add_u32 v237, v15, 2, v14
    v_add_u32 v12, v12, v244
    v_lshrrev_b32 v15, 5, v12
    v_add_u32 v15, v15, v12
    v_lshl_add_u32 v238, v15, 2, v14
    v_add_u32 v12, v12, v244
    v_lshrrev_b32 v15, 5, v12
    v_add_u32 v15, v15, v12
    v_lshl_add_u32 v239, v15, 2, v14
    v_lshrrev_b32 v15, 5, v13
    v_add_u32 v15, v15, v13
    v_lshl_add_u32 v250, v15, 2, v14
    v_add_u32 v13, v13, v245
    v_lshrrev_b32 v15, 5, v13
    v_add_u32 v15, v15, v13
    v_lshl_add_u32 v251, v15, 2, v14
    v_add_u32 v13, v13, v245
    v_lshrrev_b32 v15, 5, v13
    v_add_u32 v15, v15, v13
    v_lshl_add_u32 v252, v15, 2, v14
    v_add_u32 v13, v13, v245
    v_lshrrev_b32 v15, 5, v13
    v_add_u32 v15, v15, v13
    v_lshl_add_u32 v253, v15, 2, v14
    v_mov_b32 v240, 0
    v_mov_b32 v241, 0
    v_mov_b32 v242, 0
    v_mov_b32 v243, 0
    v_mov_b32 v10, 123552
    ds_write_b32 v10, v240
    ds_write_b32 v10, v240 offset:3200
    v_lshlrev_b32 v10, 4, v1
    v_add_u32 v10, 126784, v10
    v_cmp_gt_u32 vcc, 30, v1
    s_and_saveexec_b64 s[52:53], vcc
    ds_write_b128 v10, v[240:243]
    ds_write_b128 v10, v[240:243] offset:4576
    s_mov_b64 exec, s[52:53]
    s_lshr_b32 s54, s3, 1
    s_mul_i32 s54, s54, 60192
    s_and_b32 s55, s3, 1
    s_lshl_b32 s55, s55, 8
    s_add_u32 s54, s54, s55
    s_mov_b32 s49, s54
    v_mul_u32_u24 v57, 144, v54
    v_lshl_add_u32 v57, v55, 4, v57
    v_add_u32 v57, 144128, v57
    v_lshrrev_b32 v58, 4, v1
    v_bfe_u32 v59, v1, 2, 2
    v_lshl_add_u32 v59, v58, 3, v59
    v_mul_u32_u24 v59, 144, v59
    v_and_b32 v60, 3, v1
    v_lshlrev_b32 v60, 3, v60
    v_lshl_add_u32 v60, v2, 5, v60
    v_add_u32 v59, v59, v60
    v_add_u32 v59, 144128, v59
    v_and_b32 v128, 15, v1
    v_lshrrev_b32 v129, 4, v1
    v_xor_b32 v129, v129, v128
    v_and_b32 v129, 7, v129
    v_lshlrev_b32 v130, 7, v128
    v_lshl_add_u32 v130, v129, 4, v130
    s_lshl_b32 s53, s3, 11
    s_add_u32 s53, s53, 153344
    v_add_u32 v130, s53, v130
    v_xor_b32 v131, 64, v130
    v_lshrrev_b32 v128, 3, v1
    v_and_b32 v129, 7, v1
    v_xor_b32 v132, v128, v129
    v_lshlrev_b32 v132, 4, v132
    v_lshl_add_u32 v132, v128, 7, v132
    v_add_u32 v132, s53, v132
    s_lshl_b32 s53, s91, 6
    v_lshl_add_u32 v133, v2, 4, v128
    v_add_u32 v133, s53, v133
    v_mul_u32_u24 v133, 4224, v133
    v_lshl_add_u32 v133, v129, 4, v133
    s_lshl_b32 s53, s90, 7
    v_add_u32 v133, s53, v133
    v_lshrrev_b32 v134, 4, v1
    v_lshl_add_u32 v134, v2, 2, v134
    v_lshlrev_b32 v134, 3, v134
    v_add_u32 v134, 161536, v134
    s_waitcnt vmcnt(12)
    ds_write_b128 v57, v[44:47]
    ds_write_b128 v57, v[48:51] offset:4608
    s_mov_b32 s59, 0xffff0000
    v_lshlrev_b32 v64, 16, v28
    v_and_b32 v65, s59, v28
    v_lshlrev_b32 v66, 16, v29
    v_and_b32 v67, s59, v29
    v_lshlrev_b32 v68, 16, v30
    v_and_b32 v69, s59, v30
    v_lshlrev_b32 v70, 16, v31
    v_and_b32 v71, s59, v31
    v_lshlrev_b32 v72, 16, v32
    v_and_b32 v73, s59, v32
    v_lshlrev_b32 v74, 16, v33
    v_and_b32 v75, s59, v33
    v_lshlrev_b32 v76, 16, v34
    v_and_b32 v77, s59, v34
    v_lshlrev_b32 v78, 16, v35
    v_and_b32 v79, s59, v35
    v_lshlrev_b32 v80, 16, v36
    v_and_b32 v81, s59, v36
    v_lshlrev_b32 v82, 16, v37
    v_and_b32 v83, s59, v37
    v_lshlrev_b32 v84, 16, v38
    v_and_b32 v85, s59, v38
    v_lshlrev_b32 v86, 16, v39
    v_and_b32 v87, s59, v39
    v_lshlrev_b32 v88, 16, v40
    v_and_b32 v89, s59, v40
    v_lshlrev_b32 v90, 16, v41
    v_and_b32 v91, s59, v41
    v_pk_add_f32 v[92:93], v[64:65], v[66:67]
    v_pk_add_f32 v[94:95], v[68:69], v[70:71]
    v_pk_add_f32 v[92:93], v[92:93], v[72:73]
    v_pk_add_f32 v[94:95], v[94:95], v[74:75]
    v_pk_add_f32 v[92:93], v[92:93], v[76:77]
    v_pk_add_f32 v[94:95], v[94:95], v[78:79]
    v_pk_add_f32 v[92:93], v[92:93], v[80:81]
    v_pk_add_f32 v[94:95], v[94:95], v[82:83]
    v_pk_add_f32 v[92:93], v[92:93], v[84:85]
    v_pk_add_f32 v[94:95], v[94:95], v[86:87]
    v_pk_add_f32 v[92:93], v[92:93], v[88:89]
    v_pk_add_f32 v[94:95], v[94:95], v[90:91]
    v_pk_add_f32 v[92:93], v[92:93], v[94:95]
    v_add_f32 v92, v92, v93
    s_nop 1
    v_add_f32_dpp v92, v92, v92 row_ror:8 row_mask:0xf bank_mask:0xf
    s_nop 1
    v_add_f32_dpp v92, v92, v92 row_ror:4 row_mask:0xf bank_mask:0xf
    s_nop 1
    v_add_f32_dpp v92, v92, v92 row_ror:2 row_mask:0xf bank_mask:0xf
    s_nop 1
    v_add_f32_dpp v92, v92, v92 row_ror:1 row_mask:0xf bank_mask:0xf
    v_mul_f32 v96, 0xbb124925, v92
    v_pk_add_f32 v[64:65], v[64:65], v[96:97] op_sel_hi:[1,0]
    v_pk_add_f32 v[66:67], v[66:67], v[96:97] op_sel_hi:[1,0]
    v_pk_add_f32 v[68:69], v[68:69], v[96:97] op_sel_hi:[1,0]
    v_pk_add_f32 v[70:71], v[70:71], v[96:97] op_sel_hi:[1,0]
    v_pk_add_f32 v[72:73], v[72:73], v[96:97] op_sel_hi:[1,0]
    v_pk_add_f32 v[74:75], v[74:75], v[96:97] op_sel_hi:[1,0]
    v_pk_add_f32 v[76:77], v[76:77], v[96:97] op_sel_hi:[1,0]
    v_pk_add_f32 v[78:79], v[78:79], v[96:97] op_sel_hi:[1,0]
    v_pk_add_f32 v[80:81], v[80:81], v[96:97] op_sel_hi:[1,0]
    v_pk_add_f32 v[82:83], v[82:83], v[96:97] op_sel_hi:[1,0]
    v_pk_add_f32 v[84:85], v[84:85], v[96:97] op_sel_hi:[1,0]
    v_pk_add_f32 v[86:87], v[86:87], v[96:97] op_sel_hi:[1,0]
    v_pk_add_f32 v[88:89], v[88:89], v[96:97] op_sel_hi:[1,0]
    v_pk_add_f32 v[90:91], v[90:91], v[96:97] op_sel_hi:[1,0]
    v_pk_mul_f32 v[92:93], v[64:65], v[64:65]
    v_pk_mul_f32 v[94:95], v[66:67], v[66:67]
    v_pk_fma_f32 v[92:93], v[68:69], v[68:69], v[92:93]
    v_pk_fma_f32 v[94:95], v[70:71], v[70:71], v[94:95]
    v_pk_fma_f32 v[92:93], v[72:73], v[72:73], v[92:93]
    v_pk_fma_f32 v[94:95], v[74:75], v[74:75], v[94:95]
    v_pk_fma_f32 v[92:93], v[76:77], v[76:77], v[92:93]
    v_pk_fma_f32 v[94:95], v[78:79], v[78:79], v[94:95]
    v_pk_fma_f32 v[92:93], v[80:81], v[80:81], v[92:93]
    v_pk_fma_f32 v[94:95], v[82:83], v[82:83], v[94:95]
    v_pk_fma_f32 v[92:93], v[84:85], v[84:85], v[92:93]
    v_pk_fma_f32 v[94:95], v[86:87], v[86:87], v[94:95]
    v_pk_fma_f32 v[92:93], v[88:89], v[88:89], v[92:93]
    v_pk_fma_f32 v[94:95], v[90:91], v[90:91], v[94:95]
    v_pk_add_f32 v[92:93], v[92:93], v[94:95]
    v_add_f32 v92, v92, v93
    s_nop 1
    v_add_f32_dpp v92, v92, v92 row_ror:8 row_mask:0xf bank_mask:0xf
    s_nop 1
    v_add_f32_dpp v92, v92, v92 row_ror:4 row_mask:0xf bank_mask:0xf
    s_nop 1
    v_add_f32_dpp v92, v92, v92 row_ror:2 row_mask:0xf bank_mask:0xf
    s_nop 1
    v_add_f32_dpp v92, v92, v92 row_ror:1 row_mask:0xf bank_mask:0xf
    v_mul_f32 v92, 0x3b124925, v92
    v_cvt_pk_bf16_f32 v98, -v96, v92
    v_and_b32 v92, s59, v98
    v_lshlrev_b32 v98, 16, v98
    v_add_f32 v92, 0x3727c5ac, v92
    v_cvt_pk_bf16_f32 v92, v92, v92
    v_lshlrev_b32 v92, 16, v92
    v_sqrt_f32 v92, v92
    s_nop 0
    v_cvt_pk_bf16_f32 v92, v92, v92
    v_lshlrev_b32 v92, 16, v92
    v_rcp_f32 v99, v92
    ds_write_b64 v134, v[98:99]
    s_waitcnt vmcnt(0) lgkmcnt(0)
    s_barrier
    ds_read_b64_tr_b16 v[192:193], v59
    ds_read_b64_tr_b16 v[194:195], v59 offset:576
    ds_read_b64_tr_b16 v[196:197], v59 offset:4608
    ds_read_b64_tr_b16 v[198:199], v59 offset:5184
    v_lshlrev_b32 v135, 4, v1
    v_add_u32 v136, 161536, v135
    ds_read_b128 v[168:171], v136
    v_mov_b32 v137, 0x40000000
    v_lshlrev_b32 v60, 8, v0
    v_add_u32 v60, 0x1e0000, v60
    s_cmp_eq_u32 s2, 0
    s_cselect_b32 s52, 32, 0
    v_cmp_gt_u32 vcc, s52, v0
    s_nop 1
    v_cndmask_b32 v60, v137, v60, vcc
    buffer_store_dword v240, v60, s[40:43], 0 offen sc0 sc1
    s_lshl_b32 s53, s2, 7
    s_add_u32 s53, s53, 0x1d0000
    v_add_u32 v135, s53, v135
    s_cmp_lt_u32 s2, 128
    s_cselect_b32 s52, 8, 0
    v_cmp_gt_u32 vcc, s52, v0
    s_nop 1
    v_cndmask_b32 v135, v137, v135, vcc
    s_waitcnt lgkmcnt(0)
    ds_write_b128 v130, v[192:195]
    ds_write_b128 v131, v[196:199]
    buffer_store_dwordx4 v[168:171], v135, s[40:43], 0 offen sc0 sc1
    s_lshr_b32 s56, s3, 1
    s_lshl_b32 s56, s56, 4
    s_lshr_b32 s57, s96, s56
    s_lshl_b32 s57, s57, 16
    s_lshr_b32 s58, s97, s56
    s_lshl_b32 s58, s58, 16
    v_mov_b32 v10, 0x3fb8aa3b
    v_mul_f32 v10, s57, v10
    v_exp_f32 v10, v10
    s_nop 0
    v_cvt_pk_bf16_f32 v15, v10, v10
    v_lshlrev_b32 v15, 16, v15
    v_lshlrev_b32 v16, 16, v16
    v_lshlrev_b32 v17, 16, v17
    v_lshlrev_b32 v18, 16, v18
    v_lshlrev_b32 v19, 16, v19
    v_lshlrev_b32 v20, 16, v20
    v_lshlrev_b32 v21, 16, v21
    v_lshlrev_b32 v22, 16, v22
    v_lshlrev_b32 v23, 16, v23
    v_lshlrev_b32 v24, 16, v24
    v_lshlrev_b32 v25, 16, v25
    v_lshlrev_b32 v26, 16, v26
    v_lshlrev_b32 v27, 16, v27
    v_mul_f32 v16, v16, v15
    s_waitcnt lgkmcnt(0)
    ds_read_b128 v[192:195], v132
    ds_read_b128 v[196:199], v132 offset:1024
    v_mul_f32 v17, v17, v15
    v_mul_f32 v18, v18, v15
    v_mul_f32 v19, v19, v15
    v_mul_f32 v20, v20, v15
    v_mul_f32 v21, v21, v15
    v_mul_f32 v22, v22, v15
    v_mul_f32 v23, v23, v15
    v_mul_f32 v16, 0x3fb8aa3b, v16
    v_mul_f32 v17, 0x3fb8aa3b, v17
    v_mul_f32 v18, 0x3e22f983, v18
    v_mul_f32 v19, 0x3e22f983, v19
    v_mul_f32 v42, v24, v20
    v_mul_f32 v106, v25, v21
    v_mul_f32 v43, v24, v22
    v_mul_f32 v107, v25, v23
    v_fma_f32 v42, -v26, v22, v42
    v_fma_f32 v106, -v27, v23, v106
    v_fma_f32 v43, v26, v20, v43
    v_fma_f32 v107, v27, v21, v107
    v_sub_f32 v43, 0, v43
    v_sub_f32 v107, 0, v107
    v_exp_f32 v44, v16
    v_exp_f32 v108, v17
    v_fract_f32 v45, v18
    s_waitcnt lgkmcnt(0)
    buffer_store_dwordx4 v[192:195], v133, s[40:43], 0 offen sc0 sc1
    s_mov_b32 s53, 33792
    buffer_store_dwordx4 v[196:199], v133, s[40:43], s53 offen sc0 sc1
    s_mov_b32 m0, s49
    v_fract_f32 v109, v19
    v_cos_f32 v32, v45
    v_cos_f32 v96, v109
    v_sin_f32 v33, v45
    v_sin_f32 v97, v109
    v_mul_f32 v32, v32, v44
    v_mul_f32 v96, v96, v108
    v_mul_f32 v33, v33, v44
    v_mul_f32 v97, v97, v108
    v_mul_f32 v44, 0x41000000, v16
    v_mul_f32 v108, 0x41000000, v17
    v_mul_f32 v45, 0x41000000, v18
    v_mul_f32 v109, 0x41000000, v19
    v_exp_f32 v44, v44
    v_exp_f32 v108, v108
    v_fract_f32 v45, v45
    v_fract_f32 v109, v109
    v_cos_f32 v34, v45
    v_cos_f32 v98, v109
    v_sin_f32 v35, v45
    v_sin_f32 v99, v109
    v_mul_f32 v34, v34, v44
    v_mul_f32 v98, v98, v108
    v_mul_f32 v35, v35, v44
    v_mul_f32 v99, v99, v108
    v_mul_f32 v44, 0x43000000, v16
    v_mul_f32 v108, 0x43000000, v17
    v_mul_f32 v45, 0x43000000, v18
    v_mul_f32 v109, 0x43000000, v19
    v_exp_f32 v44, v44
    v_exp_f32 v108, v108
    v_fract_f32 v45, v45
    v_fract_f32 v109, v109
    v_cos_f32 v36, v45
    v_cos_f32 v100, v109
    v_sin_f32 v37, v45
    v_sin_f32 v101, v109
    v_mul_f32 v36, v36, v44
    v_mul_f32 v100, v100, v108
    v_mul_f32 v37, v37, v44
    v_mul_f32 v101, v101, v108
    v_pk_mul_f32 v[38:39], v[36:37], v[36:37] op_sel:[0,0] op_sel_hi:[0,1]
    v_pk_mul_f32 v[102:103], v[100:101], v[100:101] op_sel:[0,0] op_sel_hi:[0,1]
    v_pk_fma_f32 v[38:39], v[36:37], v[36:37], v[38:39] op_sel:[1,1,0] op_sel_hi:[1,0,1] neg_lo:[1,0,0]
    v_pk_fma_f32 v[102:103], v[100:101], v[100:101], v[102:103] op_sel:[1,1,0] op_sel_hi:[1,0,1] neg_lo:[1,0,0]
    v_pk_mul_f32 v[40:41], v[38:39], v[38:39] op_sel:[0,0] op_sel_hi:[0,1]
    v_pk_mul_f32 v[104:105], v[102:103], v[102:103] op_sel:[0,0] op_sel_hi:[0,1]
    v_pk_fma_f32 v[40:41], v[38:39], v[38:39], v[40:41] op_sel:[1,1,0] op_sel_hi:[1,0,1] neg_lo:[1,0,0]
    v_pk_fma_f32 v[104:105], v[102:103], v[102:103], v[104:105] op_sel:[1,1,0] op_sel_hi:[1,0,1] neg_lo:[1,0,0]
    v_cvt_pk_bf16_f32 v93, v42, v43
    v_cvt_pk_bf16_f32 v157, v106, v107
    v_mov_b32 v94, 0x3f80
    v_mov_b32 v158, 0x3f80
    ds_write_addtid_b32 v93 offset:16896
    ds_write_addtid_b32 v157 offset:17408
    v_pk_mul_f32 v[52:53], v[42:43], v[36:37] op_sel:[0,0] op_sel_hi:[0,1] neg_hi:[0,1]
    v_pk_mul_f32 v[116:117], v[106:107], v[100:101] op_sel:[0,0] op_sel_hi:[0,1] neg_hi:[0,1]
    ds_write_addtid_b32 v94 offset:0
    ds_write_addtid_b32 v158 offset:512
    v_pk_fma_f32 v[52:53], v[42:43], v[36:37], v[52:53] op_sel:[1,1,0] op_sel_hi:[1,0,1]
    v_pk_fma_f32 v[116:117], v[106:107], v[100:101], v[116:117] op_sel:[1,1,0] op_sel_hi:[1,0,1]
    v_cvt_pk_bf16_f32 v95, v52, v53
    v_cvt_pk_bf16_f32 v159, v116, v117
    ds_write_addtid_b32 v95 offset:25344
    ds_write_addtid_b32 v159 offset:25856
    v_cvt_pk_bf16_f32 v92, v34, v35
    v_cvt_pk_bf16_f32 v156, v98, v99
    v_pk_mul_f32 v[48:49], v[42:43], v[32:33] op_sel:[0,0] op_sel_hi:[0,1] neg_hi:[0,1]
    v_pk_mul_f32 v[112:113], v[106:107], v[96:97] op_sel:[0,0] op_sel_hi:[0,1] neg_hi:[0,1]
    v_pk_fma_f32 v[48:49], v[42:43], v[32:33], v[48:49] op_sel:[1,1,0] op_sel_hi:[1,0,1]
    v_pk_fma_f32 v[112:113], v[106:107], v[96:97], v[112:113] op_sel:[1,1,0] op_sel_hi:[1,0,1]
    v_cvt_pk_bf16_f32 v93, v48, v49
    v_cvt_pk_bf16_f32 v157, v112, v113
    ds_write_addtid_b32 v92 offset:1056
    ds_write_addtid_b32 v156 offset:1568
    ds_write_addtid_b32 v93 offset:17952
    ds_write_addtid_b32 v157 offset:18464
    v_pk_mul_f32 v[50:51], v[48:49], v[36:37] op_sel:[0,0] op_sel_hi:[0,1] neg_hi:[0,1]
    v_pk_mul_f32 v[114:115], v[112:113], v[100:101] op_sel:[0,0] op_sel_hi:[0,1] neg_hi:[0,1]
    v_pk_mul_f32 v[44:45], v[34:35], v[34:35] op_sel:[0,0] op_sel_hi:[0,1]
    v_pk_mul_f32 v[108:109], v[98:99], v[98:99] op_sel:[0,0] op_sel_hi:[0,1]
    v_pk_fma_f32 v[50:51], v[48:49], v[36:37], v[50:51] op_sel:[1,1,0] op_sel_hi:[1,0,1]
    v_pk_fma_f32 v[114:115], v[112:113], v[100:101], v[114:115] op_sel:[1,1,0] op_sel_hi:[1,0,1]
    v_cvt_pk_bf16_f32 v95, v50, v51
    v_cvt_pk_bf16_f32 v159, v114, v115
    ds_write_addtid_b32 v95 offset:26400
    ds_write_addtid_b32 v159 offset:26912
    v_pk_fma_f32 v[44:45], v[34:35], v[34:35], v[44:45] op_sel:[1,1,0] op_sel_hi:[1,0,1] neg_lo:[1,0,0]
    v_pk_fma_f32 v[108:109], v[98:99], v[98:99], v[108:109] op_sel:[1,1,0] op_sel_hi:[1,0,1] neg_lo:[1,0,0]
    v_pk_mul_f32 v[54:55], v[48:49], v[32:33] op_sel:[0,0] op_sel_hi:[0,1] neg_hi:[0,1]
    v_pk_mul_f32 v[118:119], v[112:113], v[96:97] op_sel:[0,0] op_sel_hi:[0,1] neg_hi:[0,1]
    v_pk_fma_f32 v[54:55], v[48:49], v[32:33], v[54:55] op_sel:[1,1,0] op_sel_hi:[1,0,1]
    v_pk_fma_f32 v[118:119], v[112:113], v[96:97], v[118:119] op_sel:[1,1,0] op_sel_hi:[1,0,1]
    v_cvt_pk_bf16_f32 v93, v54, v55
    v_cvt_pk_bf16_f32 v157, v118, v119
    v_cvt_pk_bf16_f32 v94, v44, v45
    v_cvt_pk_bf16_f32 v158, v108, v109
    ds_write_addtid_b32 v93 offset:19008
    ds_write_addtid_b32 v157 offset:19520
    v_pk_mul_f32 v[56:57], v[54:55], v[36:37] op_sel:[0,0] op_sel_hi:[0,1] neg_hi:[0,1]
    v_pk_mul_f32 v[120:121], v[118:119], v[100:101] op_sel:[0,0] op_sel_hi:[0,1] neg_hi:[0,1]
    ds_write_addtid_b32 v94 offset:2112
    ds_write_addtid_b32 v158 offset:2624
    v_pk_fma_f32 v[56:57], v[54:55], v[36:37], v[56:57] op_sel:[1,1,0] op_sel_hi:[1,0,1]
    v_pk_fma_f32 v[120:121], v[118:119], v[100:101], v[120:121] op_sel:[1,1,0] op_sel_hi:[1,0,1]
    v_cvt_pk_bf16_f32 v95, v56, v57
    v_cvt_pk_bf16_f32 v159, v120, v121
    ds_write_addtid_b32 v95 offset:27456
    ds_write_addtid_b32 v159 offset:27968
    v_pk_mul_f32 v[46:47], v[44:45], v[34:35] op_sel:[0,0] op_sel_hi:[0,1]
    v_pk_mul_f32 v[110:111], v[108:109], v[98:99] op_sel:[0,0] op_sel_hi:[0,1]
    v_pk_mul_f32 v[48:49], v[54:55], v[32:33] op_sel:[0,0] op_sel_hi:[0,1] neg_hi:[0,1]
    v_pk_mul_f32 v[112:113], v[118:119], v[96:97] op_sel:[0,0] op_sel_hi:[0,1] neg_hi:[0,1]
    v_pk_fma_f32 v[48:49], v[54:55], v[32:33], v[48:49] op_sel:[1,1,0] op_sel_hi:[1,0,1]
    v_pk_fma_f32 v[112:113], v[118:119], v[96:97], v[112:113] op_sel:[1,1,0] op_sel_hi:[1,0,1]
    v_cvt_pk_bf16_f32 v93, v48, v49
    v_cvt_pk_bf16_f32 v157, v112, v113
    v_pk_fma_f32 v[46:47], v[44:45], v[34:35], v[46:47] op_sel:[1,1,0] op_sel_hi:[1,0,1] neg_lo:[1,0,0]
    v_pk_fma_f32 v[110:111], v[108:109], v[98:99], v[110:111] op_sel:[1,1,0] op_sel_hi:[1,0,1] neg_lo:[1,0,0]
    ds_write_addtid_b32 v93 offset:20064
    ds_write_addtid_b32 v157 offset:20576
    v_pk_mul_f32 v[50:51], v[48:49], v[36:37] op_sel:[0,0] op_sel_hi:[0,1] neg_hi:[0,1]
    v_pk_mul_f32 v[114:115], v[112:113], v[100:101] op_sel:[0,0] op_sel_hi:[0,1] neg_hi:[0,1]
    v_pk_fma_f32 v[50:51], v[48:49], v[36:37], v[50:51] op_sel:[1,1,0] op_sel_hi:[1,0,1]
    v_pk_fma_f32 v[114:115], v[112:113], v[100:101], v[114:115] op_sel:[1,1,0] op_sel_hi:[1,0,1]
    v_cvt_pk_bf16_f32 v92, v46, v47
    v_cvt_pk_bf16_f32 v156, v110, v111
    v_cvt_pk_bf16_f32 v95, v50, v51
    v_cvt_pk_bf16_f32 v159, v114, v115
    ds_write_addtid_b32 v95 offset:28512
    ds_write_addtid_b32 v159 offset:29024
    ds_write_addtid_b32 v92 offset:3168
    ds_write_addtid_b32 v156 offset:3680
    v_pk_mul_f32 v[58:59], v[48:49], v[32:33] op_sel:[0,0] op_sel_hi:[0,1] neg_hi:[0,1]
    v_pk_mul_f32 v[122:123], v[112:113], v[96:97] op_sel:[0,0] op_sel_hi:[0,1] neg_hi:[0,1]
    v_pk_fma_f32 v[58:59], v[48:49], v[32:33], v[58:59] op_sel:[1,1,0] op_sel_hi:[1,0,1]
    v_pk_fma_f32 v[122:123], v[112:113], v[96:97], v[122:123] op_sel:[1,1,0] op_sel_hi:[1,0,1]
    v_cvt_pk_bf16_f32 v93, v58, v59
    v_cvt_pk_bf16_f32 v157, v122, v123
    v_pk_mul_f32 v[44:45], v[46:47], v[34:35] op_sel:[0,0] op_sel_hi:[0,1]
    v_pk_mul_f32 v[108:109], v[110:111], v[98:99] op_sel:[0,0] op_sel_hi:[0,1]
    ds_write_addtid_b32 v93 offset:21120
    ds_write_addtid_b32 v157 offset:21632
    v_pk_mul_f32 v[60:61], v[58:59], v[36:37] op_sel:[0,0] op_sel_hi:[0,1] neg_hi:[0,1]
    v_pk_mul_f32 v[124:125], v[122:123], v[100:101] op_sel:[0,0] op_sel_hi:[0,1] neg_hi:[0,1]
    v_pk_fma_f32 v[60:61], v[58:59], v[36:37], v[60:61] op_sel:[1,1,0] op_sel_hi:[1,0,1]
    v_pk_fma_f32 v[124:125], v[122:123], v[100:101], v[124:125] op_sel:[1,1,0] op_sel_hi:[1,0,1]
    v_pk_fma_f32 v[44:45], v[46:47], v[34:35], v[44:45] op_sel:[1,1,0] op_sel_hi:[1,0,1] neg_lo:[1,0,0]
    v_pk_fma_f32 v[108:109], v[110:111], v[98:99], v[108:109] op_sel:[1,1,0] op_sel_hi:[1,0,1] neg_lo:[1,0,0]
    v_cvt_pk_bf16_f32 v95, v60, v61
    v_cvt_pk_bf16_f32 v159, v124, v125
    ds_write_addtid_b32 v95 offset:29568
    ds_write_addtid_b32 v159 offset:30080
    v_cvt_pk_bf16_f32 v94, v44, v45
    v_cvt_pk_bf16_f32 v158, v108, v109
    v_pk_mul_f32 v[48:49], v[58:59], v[32:33] op_sel:[0,0] op_sel_hi:[0,1] neg_hi:[0,1]
    v_pk_mul_f32 v[112:113], v[122:123], v[96:97] op_sel:[0,0] op_sel_hi:[0,1] neg_hi:[0,1]
    v_pk_fma_f32 v[48:49], v[58:59], v[32:33], v[48:49] op_sel:[1,1,0] op_sel_hi:[1,0,1]
    v_pk_fma_f32 v[112:113], v[122:123], v[96:97], v[112:113] op_sel:[1,1,0] op_sel_hi:[1,0,1]
    v_cvt_pk_bf16_f32 v93, v48, v49
    v_cvt_pk_bf16_f32 v157, v112, v113
    ds_write_addtid_b32 v94 offset:4224
    ds_write_addtid_b32 v158 offset:4736
    ds_write_addtid_b32 v93 offset:22176
    ds_write_addtid_b32 v157 offset:22688
    v_pk_mul_f32 v[50:51], v[48:49], v[36:37] op_sel:[0,0] op_sel_hi:[0,1] neg_hi:[0,1]
    v_pk_mul_f32 v[114:115], v[112:113], v[100:101] op_sel:[0,0] op_sel_hi:[0,1] neg_hi:[0,1]
    v_pk_fma_f32 v[50:51], v[48:49], v[36:37], v[50:51] op_sel:[1,1,0] op_sel_hi:[1,0,1]
    v_pk_fma_f32 v[114:115], v[112:113], v[100:101], v[114:115] op_sel:[1,1,0] op_sel_hi:[1,0,1]
    v_pk_mul_f32 v[46:47], v[44:45], v[34:35] op_sel:[0,0] op_sel_hi:[0,1]
    v_pk_mul_f32 v[110:111], v[108:109], v[98:99] op_sel:[0,0] op_sel_hi:[0,1]
    v_cvt_pk_bf16_f32 v95, v50, v51
    v_cvt_pk_bf16_f32 v159, v114, v115
    ds_write_addtid_b32 v95 offset:30624
    ds_write_addtid_b32 v159 offset:31136
    v_pk_fma_f32 v[46:47], v[44:45], v[34:35], v[46:47] op_sel:[1,1,0] op_sel_hi:[1,0,1] neg_lo:[1,0,0]
    v_pk_fma_f32 v[110:111], v[108:109], v[98:99], v[110:111] op_sel:[1,1,0] op_sel_hi:[1,0,1] neg_lo:[1,0,0]
    v_pk_mul_f32 v[62:63], v[48:49], v[32:33] op_sel:[0,0] op_sel_hi:[0,1] neg_hi:[0,1]
    v_pk_mul_f32 v[126:127], v[112:113], v[96:97] op_sel:[0,0] op_sel_hi:[0,1] neg_hi:[0,1]
    v_pk_fma_f32 v[62:63], v[48:49], v[32:33], v[62:63] op_sel:[1,1,0] op_sel_hi:[1,0,1]
    v_pk_fma_f32 v[126:127], v[112:113], v[96:97], v[126:127] op_sel:[1,1,0] op_sel_hi:[1,0,1]
    v_cvt_pk_bf16_f32 v93, v62, v63
    s_waitcnt vmcnt(0)
    s_barrier
    s_cmp_eq_u32 s3, 0
    s_cbranch_scc0 ARR_S1
    s_mov_b64 s[92:93], exec
    s_mov_b64 exec, 1
    s_and_b32 s94, s2, 3
    s_lshl_b32 s94, s94, 6
    v_mov_b32 v244, s94
    v_mov_b32 v245, 1
    global_atomic_add v244, v245, s[36:37] sc1
    s_mov_b64 exec, s[92:93]
ARR_S1:
    s_mov_b32 m0, s49
    v_cvt_pk_bf16_f32 v157, v126, v127
    v_cvt_pk_bf16_f32 v92, v46, v47
    v_cvt_pk_bf16_f32 v156, v110, v111
    ds_write_addtid_b32 v93 offset:23232
    ds_write_addtid_b32 v157 offset:23744
    v_pk_mul_f32 v[64:65], v[62:63], v[36:37] op_sel:[0,0] op_sel_hi:[0,1] neg_hi:[0,1]
    v_pk_mul_f32 v[128:129], v[126:127], v[100:101] op_sel:[0,0] op_sel_hi:[0,1] neg_hi:[0,1]
    v_pk_fma_f32 v[64:65], v[62:63], v[36:37], v[64:65] op_sel:[1,1,0] op_sel_hi:[1,0,1]
    v_pk_fma_f32 v[128:129], v[126:127], v[100:101], v[128:129] op_sel:[1,1,0] op_sel_hi:[1,0,1]
    ds_write_addtid_b32 v92 offset:5280
    ds_write_addtid_b32 v156 offset:5792
    v_cvt_pk_bf16_f32 v95, v64, v65
    v_cvt_pk_bf16_f32 v159, v128, v129
    ds_write_addtid_b32 v95 offset:31680
    ds_write_addtid_b32 v159 offset:32192
    v_pk_mul_f32 v[48:49], v[62:63], v[32:33] op_sel:[0,0] op_sel_hi:[0,1] neg_hi:[0,1]
    v_pk_mul_f32 v[112:113], v[126:127], v[96:97] op_sel:[0,0] op_sel_hi:[0,1] neg_hi:[0,1]
    v_pk_mul_f32 v[44:45], v[46:47], v[34:35] op_sel:[0,0] op_sel_hi:[0,1]
    v_pk_mul_f32 v[108:109], v[110:111], v[98:99] op_sel:[0,0] op_sel_hi:[0,1]
    v_pk_fma_f32 v[48:49], v[62:63], v[32:33], v[48:49] op_sel:[1,1,0] op_sel_hi:[1,0,1]
    v_pk_fma_f32 v[112:113], v[126:127], v[96:97], v[112:113] op_sel:[1,1,0] op_sel_hi:[1,0,1]
    v_cvt_pk_bf16_f32 v93, v48, v49
    v_cvt_pk_bf16_f32 v157, v112, v113
    v_pk_fma_f32 v[44:45], v[46:47], v[34:35], v[44:45] op_sel:[1,1,0] op_sel_hi:[1,0,1] neg_lo:[1,0,0]
    v_pk_fma_f32 v[108:109], v[110:111], v[98:99], v[108:109] op_sel:[1,1,0] op_sel_hi:[1,0,1] neg_lo:[1,0,0]
    ds_write_addtid_b32 v93 offset:24288
    ds_write_addtid_b32 v157 offset:24800
    v_pk_mul_f32 v[50:51], v[48:49], v[36:37] op_sel:[0,0] op_sel_hi:[0,1] neg_hi:[0,1]
    v_pk_mul_f32 v[114:115], v[112:113], v[100:101] op_sel:[0,0] op_sel_hi:[0,1] neg_hi:[0,1]
    v_pk_fma_f32 v[50:51], v[48:49], v[36:37], v[50:51] op_sel:[1,1,0] op_sel_hi:[1,0,1]
    v_pk_fma_f32 v[114:115], v[112:113], v[100:101], v[114:115] op_sel:[1,1,0] op_sel_hi:[1,0,1]
    v_cvt_pk_bf16_f32 v94, v44, v45
    v_cvt_pk_bf16_f32 v158, v108, v109
    v_cvt_pk_bf16_f32 v95, v50, v51
    v_cvt_pk_bf16_f32 v159, v114, v115
    ds_write_addtid_b32 v95 offset:32736
    ds_write_addtid_b32 v159 offset:33248
    v_pk_mul_f32 v[66:67], v[42:43], v[38:39] op_sel:[0,0] op_sel_hi:[0,1] neg_hi:[0,1]
    v_pk_mul_f32 v[130:131], v[106:107], v[102:103] op_sel:[0,0] op_sel_hi:[0,1] neg_hi:[0,1]
    ds_write_addtid_b32 v94 offset:6336
    ds_write_addtid_b32 v158 offset:6848
    v_pk_fma_f32 v[66:67], v[42:43], v[38:39], v[66:67] op_sel:[1,1,0] op_sel_hi:[1,0,1]
    v_pk_fma_f32 v[130:131], v[106:107], v[102:103], v[130:131] op_sel:[1,1,0] op_sel_hi:[1,0,1]
    v_cvt_pk_bf16_f32 v93, v66, v67
    v_cvt_pk_bf16_f32 v157, v130, v131
    v_pk_mul_f32 v[46:47], v[44:45], v[34:35] op_sel:[0,0] op_sel_hi:[0,1]
    v_pk_mul_f32 v[110:111], v[108:109], v[98:99] op_sel:[0,0] op_sel_hi:[0,1]
    ds_write_addtid_b32 v93 offset:33792
    ds_write_addtid_b32 v157 offset:34304
    v_pk_mul_f32 v[48:49], v[54:55], v[38:39] op_sel:[0,0] op_sel_hi:[0,1] neg_hi:[0,1]
    v_pk_mul_f32 v[112:113], v[118:119], v[102:103] op_sel:[0,0] op_sel_hi:[0,1] neg_hi:[0,1]
    v_pk_fma_f32 v[48:49], v[54:55], v[38:39], v[48:49] op_sel:[1,1,0] op_sel_hi:[1,0,1]
    v_pk_fma_f32 v[112:113], v[118:119], v[102:103], v[112:113] op_sel:[1,1,0] op_sel_hi:[1,0,1]
    v_pk_fma_f32 v[46:47], v[44:45], v[34:35], v[46:47] op_sel:[1,1,0] op_sel_hi:[1,0,1] neg_lo:[1,0,0]
    v_pk_fma_f32 v[110:111], v[108:109], v[98:99], v[110:111] op_sel:[1,1,0] op_sel_hi:[1,0,1] neg_lo:[1,0,0]
    v_cvt_pk_bf16_f32 v95, v48, v49
    v_cvt_pk_bf16_f32 v159, v112, v113
    ds_write_addtid_b32 v95 offset:34848
    ds_write_addtid_b32 v159 offset:35360
    v_pk_mul_f32 v[68:69], v[58:59], v[38:39] op_sel:[0,0] op_sel_hi:[0,1] neg_hi:[0,1]
    v_pk_mul_f32 v[132:133], v[122:123], v[102:103] op_sel:[0,0] op_sel_hi:[0,1] neg_hi:[0,1]
    v_cvt_pk_bf16_f32 v92, v46, v47
    v_cvt_pk_bf16_f32 v156, v110, v111
    v_pk_fma_f32 v[68:69], v[58:59], v[38:39], v[68:69] op_sel:[1,1,0] op_sel_hi:[1,0,1]
    v_pk_fma_f32 v[132:133], v[122:123], v[102:103], v[132:133] op_sel:[1,1,0] op_sel_hi:[1,0,1]
    v_cvt_pk_bf16_f32 v93, v68, v69
    v_cvt_pk_bf16_f32 v157, v132, v133
    ds_write_addtid_b32 v92 offset:7392
    ds_write_addtid_b32 v156 offset:7904
    ds_write_addtid_b32 v93 offset:35904
    ds_write_addtid_b32 v157 offset:36416
    v_pk_mul_f32 v[48:49], v[62:63], v[38:39] op_sel:[0,0] op_sel_hi:[0,1] neg_hi:[0,1]
    v_pk_mul_f32 v[112:113], v[126:127], v[102:103] op_sel:[0,0] op_sel_hi:[0,1] neg_hi:[0,1]
    v_pk_fma_f32 v[48:49], v[62:63], v[38:39], v[48:49] op_sel:[1,1,0] op_sel_hi:[1,0,1]
    v_pk_fma_f32 v[112:113], v[126:127], v[102:103], v[112:113] op_sel:[1,1,0] op_sel_hi:[1,0,1]
    v_pk_mul_f32 v[44:45], v[46:47], v[34:35] op_sel:[0,0] op_sel_hi:[0,1]
    v_pk_mul_f32 v[108:109], v[110:111], v[98:99] op_sel:[0,0] op_sel_hi:[0,1]
    v_cvt_pk_bf16_f32 v95, v48, v49
    v_cvt_pk_bf16_f32 v159, v112, v113
    ds_write_addtid_b32 v95 offset:36960
    ds_write_addtid_b32 v159 offset:37472
    v_pk_mul_f32 v[70:71], v[52:53], v[38:39] op_sel:[0,0] op_sel_hi:[0,1] neg_hi:[0,1]
    v_pk_mul_f32 v[134:135], v[116:117], v[102:103] op_sel:[0,0] op_sel_hi:[0,1] neg_hi:[0,1]
    v_pk_fma_f32 v[44:45], v[46:47], v[34:35], v[44:45] op_sel:[1,1,0] op_sel_hi:[1,0,1] neg_lo:[1,0,0]
    v_pk_fma_f32 v[108:109], v[110:111], v[98:99], v[108:109] op_sel:[1,1,0] op_sel_hi:[1,0,1] neg_lo:[1,0,0]
    v_pk_fma_f32 v[70:71], v[52:53], v[38:39], v[70:71] op_sel:[1,1,0] op_sel_hi:[1,0,1]
    v_pk_fma_f32 v[134:135], v[116:117], v[102:103], v[134:135] op_sel:[1,1,0] op_sel_hi:[1,0,1]
    v_cvt_pk_bf16_f32 v93, v70, v71
    v_cvt_pk_bf16_f32 v157, v134, v135
    ds_write_addtid_b32 v93 offset:38016
    ds_write_addtid_b32 v157 offset:38528
    v_cvt_pk_bf16_f32 v94, v44, v45
    v_cvt_pk_bf16_f32 v158, v108, v109
    v_pk_mul_f32 v[48:49], v[56:57], v[38:39] op_sel:[0,0] op_sel_hi:[0,1] neg_hi:[0,1]
    v_pk_mul_f32 v[112:113], v[120:121], v[102:103] op_sel:[0,0] op_sel_hi:[0,1] neg_hi:[0,1]
    v_pk_fma_f32 v[48:49], v[56:57], v[38:39], v[48:49] op_sel:[1,1,0] op_sel_hi:[1,0,1]
    v_pk_fma_f32 v[112:113], v[120:121], v[102:103], v[112:113] op_sel:[1,1,0] op_sel_hi:[1,0,1]
    ds_write_addtid_b32 v94 offset:8448
    ds_write_addtid_b32 v158 offset:8960
    v_cvt_pk_bf16_f32 v95, v48, v49
    v_cvt_pk_bf16_f32 v159, v112, v113
    ds_write_addtid_b32 v95 offset:39072
    ds_write_addtid_b32 v159 offset:39584
    v_pk_mul_f32 v[72:73], v[60:61], v[38:39] op_sel:[0,0] op_sel_hi:[0,1] neg_hi:[0,1]
    v_pk_mul_f32 v[136:137], v[124:125], v[102:103] op_sel:[0,0] op_sel_hi:[0,1] neg_hi:[0,1]
    v_pk_mul_f32 v[46:47], v[44:45], v[34:35] op_sel:[0,0] op_sel_hi:[0,1]
    v_pk_mul_f32 v[110:111], v[108:109], v[98:99] op_sel:[0,0] op_sel_hi:[0,1]
    v_pk_fma_f32 v[72:73], v[60:61], v[38:39], v[72:73] op_sel:[1,1,0] op_sel_hi:[1,0,1]
    v_pk_fma_f32 v[136:137], v[124:125], v[102:103], v[136:137] op_sel:[1,1,0] op_sel_hi:[1,0,1]
    v_cvt_pk_bf16_f32 v93, v72, v73
    v_cvt_pk_bf16_f32 v157, v136, v137
    ds_write_addtid_b32 v93 offset:40128
    ds_write_addtid_b32 v157 offset:40640
    v_pk_fma_f32 v[46:47], v[44:45], v[34:35], v[46:47] op_sel:[1,1,0] op_sel_hi:[1,0,1] neg_lo:[1,0,0]
    v_pk_fma_f32 v[110:111], v[108:109], v[98:99], v[110:111] op_sel:[1,1,0] op_sel_hi:[1,0,1] neg_lo:[1,0,0]
    v_pk_mul_f32 v[48:49], v[64:65], v[38:39] op_sel:[0,0] op_sel_hi:[0,1] neg_hi:[0,1]
    v_pk_mul_f32 v[112:113], v[128:129], v[102:103] op_sel:[0,0] op_sel_hi:[0,1] neg_hi:[0,1]
    v_pk_fma_f32 v[48:49], v[64:65], v[38:39], v[48:49] op_sel:[1,1,0] op_sel_hi:[1,0,1]
    v_pk_fma_f32 v[112:113], v[128:129], v[102:103], v[112:113] op_sel:[1,1,0] op_sel_hi:[1,0,1]
    v_cvt_pk_bf16_f32 v92, v46, v47
    v_cvt_pk_bf16_f32 v156, v110, v111
    v_cvt_pk_bf16_f32 v95, v48, v49
    v_cvt_pk_bf16_f32 v159, v112, v113
    ds_write_addtid_b32 v95 offset:41184
    ds_write_addtid_b32 v159 offset:41696
    v_pk_mul_f32 v[54:55], v[66:67], v[38:39] op_sel:[0,0] op_sel_hi:[0,1] neg_hi:[0,1]
    v_pk_mul_f32 v[118:119], v[130:131], v[102:103] op_sel:[0,0] op_sel_hi:[0,1] neg_hi:[0,1]
    ds_write_addtid_b32 v92 offset:9504
    ds_write_addtid_b32 v156 offset:10016
    v_pk_fma_f32 v[54:55], v[66:67], v[38:39], v[54:55] op_sel:[1,1,0] op_sel_hi:[1,0,1]
    v_pk_fma_f32 v[118:119], v[130:131], v[102:103], v[118:119] op_sel:[1,1,0] op_sel_hi:[1,0,1]
    v_cvt_pk_bf16_f32 v93, v54, v55
    v_cvt_pk_bf16_f32 v157, v118, v119
    ds_write_addtid_b32 v93 offset:42240
    ds_write_addtid_b32 v157 offset:42752
    v_pk_mul_f32 v[44:45], v[46:47], v[34:35] op_sel:[0,0] op_sel_hi:[0,1]
    v_pk_mul_f32 v[108:109], v[110:111], v[98:99] op_sel:[0,0] op_sel_hi:[0,1]
    v_pk_mul_f32 v[58:59], v[68:69], v[38:39] op_sel:[0,0] op_sel_hi:[0,1] neg_hi:[0,1]
    v_pk_mul_f32 v[122:123], v[132:133], v[102:103] op_sel:[0,0] op_sel_hi:[0,1] neg_hi:[0,1]
    v_pk_fma_f32 v[58:59], v[68:69], v[38:39], v[58:59] op_sel:[1,1,0] op_sel_hi:[1,0,1]
    v_pk_fma_f32 v[122:123], v[132:133], v[102:103], v[122:123] op_sel:[1,1,0] op_sel_hi:[1,0,1]
    v_pk_fma_f32 v[44:45], v[46:47], v[34:35], v[44:45] op_sel:[1,1,0] op_sel_hi:[1,0,1] neg_lo:[1,0,0]
    v_pk_fma_f32 v[108:109], v[110:111], v[98:99], v[108:109] op_sel:[1,1,0] op_sel_hi:[1,0,1] neg_lo:[1,0,0]
    v_cvt_pk_bf16_f32 v95, v58, v59
    v_cvt_pk_bf16_f32 v159, v122, v123
    ds_write_addtid_b32 v95 offset:43296
    ds_write_addtid_b32 v159 offset:43808
    v_pk_mul_f32 v[62:63], v[70:71], v[38:39] op_sel:[0,0] op_sel_hi:[0,1] neg_hi:[0,1]
    v_pk_mul_f32 v[126:127], v[134:135], v[102:103] op_sel:[0,0] op_sel_hi:[0,1] neg_hi:[0,1]
    v_cvt_pk_bf16_f32 v94, v44, v45
    v_cvt_pk_bf16_f32 v158, v108, v109
    v_pk_fma_f32 v[62:63], v[70:71], v[38:39], v[62:63] op_sel:[1,1,0] op_sel_hi:[1,0,1]
    v_pk_fma_f32 v[126:127], v[134:135], v[102:103], v[126:127] op_sel:[1,1,0] op_sel_hi:[1,0,1]
    v_cvt_pk_bf16_f32 v93, v62, v63
    v_cvt_pk_bf16_f32 v157, v126, v127
    ds_write_addtid_b32 v93 offset:44352
    ds_write_addtid_b32 v157 offset:44864
    ds_write_addtid_b32 v94 offset:10560
    ds_write_addtid_b32 v158 offset:11072
    v_pk_mul_f32 v[52:53], v[72:73], v[38:39] op_sel:[0,0] op_sel_hi:[0,1] neg_hi:[0,1]
    v_pk_mul_f32 v[116:117], v[136:137], v[102:103] op_sel:[0,0] op_sel_hi:[0,1] neg_hi:[0,1]
    v_pk_fma_f32 v[52:53], v[72:73], v[38:39], v[52:53] op_sel:[1,1,0] op_sel_hi:[1,0,1]
    v_pk_fma_f32 v[116:117], v[136:137], v[102:103], v[116:117] op_sel:[1,1,0] op_sel_hi:[1,0,1]
    v_cvt_pk_bf16_f32 v95, v52, v53
    v_cvt_pk_bf16_f32 v159, v116, v117
    v_pk_mul_f32 v[46:47], v[44:45], v[34:35] op_sel:[0,0] op_sel_hi:[0,1]
    v_pk_mul_f32 v[110:111], v[108:109], v[98:99] op_sel:[0,0] op_sel_hi:[0,1]
    ds_write_addtid_b32 v95 offset:45408
    ds_write_addtid_b32 v159 offset:45920
    v_pk_mul_f32 v[56:57], v[54:55], v[38:39] op_sel:[0,0] op_sel_hi:[0,1] neg_hi:[0,1]
    v_pk_mul_f32 v[120:121], v[118:119], v[102:103] op_sel:[0,0] op_sel_hi:[0,1] neg_hi:[0,1]
    v_pk_fma_f32 v[46:47], v[44:45], v[34:35], v[46:47] op_sel:[1,1,0] op_sel_hi:[1,0,1] neg_lo:[1,0,0]
    v_pk_fma_f32 v[110:111], v[108:109], v[98:99], v[110:111] op_sel:[1,1,0] op_sel_hi:[1,0,1] neg_lo:[1,0,0]
    v_pk_fma_f32 v[56:57], v[54:55], v[38:39], v[56:57] op_sel:[1,1,0] op_sel_hi:[1,0,1]
    v_pk_fma_f32 v[120:121], v[118:119], v[102:103], v[120:121] op_sel:[1,1,0] op_sel_hi:[1,0,1]
    v_cvt_pk_bf16_f32 v93, v56, v57
    v_cvt_pk_bf16_f32 v157, v120, v121
    ds_write_addtid_b32 v93 offset:46464
    ds_write_addtid_b32 v157 offset:46976
    v_cvt_pk_bf16_f32 v92, v46, v47
    v_cvt_pk_bf16_f32 v156, v110, v111
    v_pk_mul_f32 v[60:61], v[58:59], v[38:39] op_sel:[0,0] op_sel_hi:[0,1] neg_hi:[0,1]
    v_pk_mul_f32 v[124:125], v[122:123], v[102:103] op_sel:[0,0] op_sel_hi:[0,1] neg_hi:[0,1]
    v_pk_fma_f32 v[60:61], v[58:59], v[38:39], v[60:61] op_sel:[1,1,0] op_sel_hi:[1,0,1]
    v_pk_fma_f32 v[124:125], v[122:123], v[102:103], v[124:125] op_sel:[1,1,0] op_sel_hi:[1,0,1]
    v_cvt_pk_bf16_f32 v95, v60, v61
    v_cvt_pk_bf16_f32 v159, v124, v125
    ds_write_addtid_b32 v92 offset:11616
    ds_write_addtid_b32 v156 offset:12128
    ds_write_addtid_b32 v95 offset:47520
    ds_write_addtid_b32 v159 offset:48032
    v_pk_mul_f32 v[64:65], v[62:63], v[38:39] op_sel:[0,0] op_sel_hi:[0,1] neg_hi:[0,1]
    v_pk_mul_f32 v[128:129], v[126:127], v[102:103] op_sel:[0,0] op_sel_hi:[0,1] neg_hi:[0,1]
    v_pk_mul_f32 v[44:45], v[46:47], v[34:35] op_sel:[0,0] op_sel_hi:[0,1]
    v_pk_mul_f32 v[108:109], v[110:111], v[98:99] op_sel:[0,0] op_sel_hi:[0,1]
    v_pk_fma_f32 v[64:65], v[62:63], v[38:39], v[64:65] op_sel:[1,1,0] op_sel_hi:[1,0,1]
    v_pk_fma_f32 v[128:129], v[126:127], v[102:103], v[128:129] op_sel:[1,1,0] op_sel_hi:[1,0,1]
    v_cvt_pk_bf16_f32 v93, v64, v65
    v_cvt_pk_bf16_f32 v157, v128, v129
    ds_write_addtid_b32 v93 offset:48576
    ds_write_addtid_b32 v157 offset:49088
    v_pk_fma_f32 v[44:45], v[46:47], v[34:35], v[44:45] op_sel:[1,1,0] op_sel_hi:[1,0,1] neg_lo:[1,0,0]
    v_pk_fma_f32 v[108:109], v[110:111], v[98:99], v[108:109] op_sel:[1,1,0] op_sel_hi:[1,0,1] neg_lo:[1,0,0]
    v_pk_mul_f32 v[48:49], v[52:53], v[38:39] op_sel:[0,0] op_sel_hi:[0,1] neg_hi:[0,1]
    v_pk_mul_f32 v[112:113], v[116:117], v[102:103] op_sel:[0,0] op_sel_hi:[0,1] neg_hi:[0,1]
    v_pk_fma_f32 v[48:49], v[52:53], v[38:39], v[48:49] op_sel:[1,1,0] op_sel_hi:[1,0,1]
    v_pk_fma_f32 v[112:113], v[116:117], v[102:103], v[112:113] op_sel:[1,1,0] op_sel_hi:[1,0,1]
    v_cvt_pk_bf16_f32 v95, v48, v49
    v_cvt_pk_bf16_f32 v159, v112, v113
    v_cvt_pk_bf16_f32 v94, v44, v45
    v_cvt_pk_bf16_f32 v158, v108, v109
    ds_write_addtid_b32 v95 offset:49632
    ds_write_addtid_b32 v159 offset:50144
    v_pk_mul_f32 v[66:67], v[54:55], v[40:41] op_sel:[0,0] op_sel_hi:[0,1] neg_hi:[0,1]
    v_pk_mul_f32 v[130:131], v[118:119], v[104:105] op_sel:[0,0] op_sel_hi:[0,1] neg_hi:[0,1]
    ds_write_addtid_b32 v94 offset:12672
    ds_write_addtid_b32 v158 offset:13184
    v_pk_fma_f32 v[66:67], v[54:55], v[40:41], v[66:67] op_sel:[1,1,0] op_sel_hi:[1,0,1]
    v_pk_fma_f32 v[130:131], v[118:119], v[104:105], v[130:131] op_sel:[1,1,0] op_sel_hi:[1,0,1]
    v_cvt_pk_bf16_f32 v93, v66, v67
    v_cvt_pk_bf16_f32 v157, v130, v131
    ds_write_addtid_b32 v93 offset:50688
    ds_write_addtid_b32 v157 offset:51200
    v_pk_mul_f32 v[46:47], v[44:45], v[34:35] op_sel:[0,0] op_sel_hi:[0,1]
    v_pk_mul_f32 v[110:111], v[108:109], v[98:99] op_sel:[0,0] op_sel_hi:[0,1]
    v_pk_mul_f32 v[68:69], v[62:63], v[40:41] op_sel:[0,0] op_sel_hi:[0,1] neg_hi:[0,1]
    v_pk_mul_f32 v[132:133], v[126:127], v[104:105] op_sel:[0,0] op_sel_hi:[0,1] neg_hi:[0,1]
    v_pk_fma_f32 v[68:69], v[62:63], v[40:41], v[68:69] op_sel:[1,1,0] op_sel_hi:[1,0,1]
    v_pk_fma_f32 v[132:133], v[126:127], v[104:105], v[132:133] op_sel:[1,1,0] op_sel_hi:[1,0,1]
    v_cvt_pk_bf16_f32 v95, v68, v69
    v_cvt_pk_bf16_f32 v159, v132, v133
    v_pk_fma_f32 v[46:47], v[44:45], v[34:35], v[46:47] op_sel:[1,1,0] op_sel_hi:[1,0,1] neg_lo:[1,0,0]
    v_pk_fma_f32 v[110:111], v[108:109], v[98:99], v[110:111] op_sel:[1,1,0] op_sel_hi:[1,0,1] neg_lo:[1,0,0]
    ds_write_addtid_b32 v95 offset:51744
    ds_write_addtid_b32 v159 offset:52256
    v_pk_mul_f32 v[70:71], v[56:57], v[40:41] op_sel:[0,0] op_sel_hi:[0,1] neg_hi:[0,1]
    v_pk_mul_f32 v[134:135], v[120:121], v[104:105] op_sel:[0,0] op_sel_hi:[0,1] neg_hi:[0,1]
    v_pk_fma_f32 v[70:71], v[56:57], v[40:41], v[70:71] op_sel:[1,1,0] op_sel_hi:[1,0,1]
    v_pk_fma_f32 v[134:135], v[120:121], v[104:105], v[134:135] op_sel:[1,1,0] op_sel_hi:[1,0,1]
    v_cvt_pk_bf16_f32 v92, v46, v47
    v_cvt_pk_bf16_f32 v156, v110, v111
    v_cvt_pk_bf16_f32 v93, v70, v71
    v_cvt_pk_bf16_f32 v157, v134, v135
    ds_write_addtid_b32 v93 offset:52800
    ds_write_addtid_b32 v157 offset:53312
    ds_write_addtid_b32 v92 offset:13728
    ds_write_addtid_b32 v156 offset:14240
    v_pk_mul_f32 v[72:73], v[64:65], v[40:41] op_sel:[0,0] op_sel_hi:[0,1] neg_hi:[0,1]
    v_pk_mul_f32 v[136:137], v[128:129], v[104:105] op_sel:[0,0] op_sel_hi:[0,1] neg_hi:[0,1]
    v_pk_fma_f32 v[72:73], v[64:65], v[40:41], v[72:73] op_sel:[1,1,0] op_sel_hi:[1,0,1]
    v_pk_fma_f32 v[136:137], v[128:129], v[104:105], v[136:137] op_sel:[1,1,0] op_sel_hi:[1,0,1]
    v_cvt_pk_bf16_f32 v95, v72, v73
    v_cvt_pk_bf16_f32 v159, v136, v137
    v_pk_mul_f32 v[44:45], v[46:47], v[34:35] op_sel:[0,0] op_sel_hi:[0,1]
    v_pk_mul_f32 v[108:109], v[110:111], v[98:99] op_sel:[0,0] op_sel_hi:[0,1]
    ds_write_addtid_b32 v95 offset:53856
    ds_write_addtid_b32 v159 offset:54368
    v_pk_mul_f32 v[54:55], v[66:67], v[40:41] op_sel:[0,0] op_sel_hi:[0,1] neg_hi:[0,1]
    v_pk_mul_f32 v[118:119], v[130:131], v[104:105] op_sel:[0,0] op_sel_hi:[0,1] neg_hi:[0,1]
    v_pk_fma_f32 v[54:55], v[66:67], v[40:41], v[54:55] op_sel:[1,1,0] op_sel_hi:[1,0,1]
    v_pk_fma_f32 v[118:119], v[130:131], v[104:105], v[118:119] op_sel:[1,1,0] op_sel_hi:[1,0,1]
    v_pk_fma_f32 v[44:45], v[46:47], v[34:35], v[44:45] op_sel:[1,1,0] op_sel_hi:[1,0,1] neg_lo:[1,0,0]
    v_pk_fma_f32 v[108:109], v[110:111], v[98:99], v[108:109] op_sel:[1,1,0] op_sel_hi:[1,0,1] neg_lo:[1,0,0]
    v_cvt_pk_bf16_f32 v93, v54, v55
    v_cvt_pk_bf16_f32 v157, v118, v119
    ds_write_addtid_b32 v93 offset:54912
    ds_write_addtid_b32 v157 offset:55424
    v_cvt_pk_bf16_f32 v94, v44, v45
    v_cvt_pk_bf16_f32 v158, v108, v109
    v_pk_mul_f32 v[62:63], v[68:69], v[40:41] op_sel:[0,0] op_sel_hi:[0,1] neg_hi:[0,1]
    v_pk_mul_f32 v[126:127], v[132:133], v[104:105] op_sel:[0,0] op_sel_hi:[0,1] neg_hi:[0,1]
    v_pk_fma_f32 v[62:63], v[68:69], v[40:41], v[62:63] op_sel:[1,1,0] op_sel_hi:[1,0,1]
    v_pk_fma_f32 v[126:127], v[132:133], v[104:105], v[126:127] op_sel:[1,1,0] op_sel_hi:[1,0,1]
    v_cvt_pk_bf16_f32 v95, v62, v63
    v_cvt_pk_bf16_f32 v159, v126, v127
    ds_write_addtid_b32 v94 offset:14784
    ds_write_addtid_b32 v158 offset:15296
    ds_write_addtid_b32 v95 offset:55968
    ds_write_addtid_b32 v159 offset:56480
    v_pk_mul_f32 v[56:57], v[70:71], v[40:41] op_sel:[0,0] op_sel_hi:[0,1] neg_hi:[0,1]
    v_pk_mul_f32 v[120:121], v[134:135], v[104:105] op_sel:[0,0] op_sel_hi:[0,1] neg_hi:[0,1]
    v_pk_fma_f32 v[56:57], v[70:71], v[40:41], v[56:57] op_sel:[1,1,0] op_sel_hi:[1,0,1]
    v_pk_fma_f32 v[120:121], v[134:135], v[104:105], v[120:121] op_sel:[1,1,0] op_sel_hi:[1,0,1]
    v_pk_mul_f32 v[46:47], v[44:45], v[34:35] op_sel:[0,0] op_sel_hi:[0,1]
    v_pk_mul_f32 v[110:111], v[108:109], v[98:99] op_sel:[0,0] op_sel_hi:[0,1]
    v_cvt_pk_bf16_f32 v93, v56, v57
    v_cvt_pk_bf16_f32 v157, v120, v121
    ds_write_addtid_b32 v93 offset:57024
    ds_write_addtid_b32 v157 offset:57536
    v_pk_fma_f32 v[46:47], v[44:45], v[34:35], v[46:47] op_sel:[1,1,0] op_sel_hi:[1,0,1] neg_lo:[1,0,0]
    v_pk_fma_f32 v[110:111], v[108:109], v[98:99], v[110:111] op_sel:[1,1,0] op_sel_hi:[1,0,1] neg_lo:[1,0,0]
    v_pk_mul_f32 v[64:65], v[72:73], v[40:41] op_sel:[0,0] op_sel_hi:[0,1] neg_hi:[0,1]
    v_pk_mul_f32 v[128:129], v[136:137], v[104:105] op_sel:[0,0] op_sel_hi:[0,1] neg_hi:[0,1]
    v_pk_fma_f32 v[64:65], v[72:73], v[40:41], v[64:65] op_sel:[1,1,0] op_sel_hi:[1,0,1]
    v_pk_fma_f32 v[128:129], v[136:137], v[104:105], v[128:129] op_sel:[1,1,0] op_sel_hi:[1,0,1]
    v_cvt_pk_bf16_f32 v95, v64, v65
    v_cvt_pk_bf16_f32 v159, v128, v129
    v_cvt_pk_bf16_f32 v92, v46, v47
    v_cvt_pk_bf16_f32 v156, v110, v111
    ds_write_addtid_b32 v95 offset:58080
    ds_write_addtid_b32 v159 offset:58592
    v_pk_mul_f32 v[50:51], v[54:55], v[40:41] op_sel:[0,0] op_sel_hi:[0,1] neg_hi:[0,1]
    v_pk_mul_f32 v[114:115], v[118:119], v[104:105] op_sel:[0,0] op_sel_hi:[0,1] neg_hi:[0,1]
    v_pk_fma_f32 v[50:51], v[54:55], v[40:41], v[50:51] op_sel:[1,1,0] op_sel_hi:[1,0,1]
    v_pk_fma_f32 v[114:115], v[118:119], v[104:105], v[114:115] op_sel:[1,1,0] op_sel_hi:[1,0,1]
    ds_write_addtid_b32 v92 offset:15840
    ds_write_addtid_b32 v156 offset:16352
    v_cvt_pk_bf16_f32 v93, v50, v51
    v_cvt_pk_bf16_f32 v157, v114, v115
    ds_write_addtid_b32 v93 offset:59136
    ds_write_addtid_b32 v157 offset:59648
    s_waitcnt lgkmcnt(0)
    s_barrier
    v_and_b32 v10, 15, v1
    v_mul_u32_u24 v10, 1056, v10
    v_lshrrev_b32 v11, 4, v1
    v_lshl_add_u32 v10, v11, 4, v10
    v_mul_u32_u24 v11, 60192, v3
    v_add_u32 v10, v10, v11
    s_and_b32 s7, s3, 1
    s_mul_i32 s90, s7, 33792
    s_add_u32 s90, s90, 16896
    v_add_u32 v11, s90, v10
    s_mul_i32 s91, s7, 16896
    s_add_u32 s91, s91, 33792
    v_add_u32 v12, s91, v10
    s_cmp_eq_u32 s7, 0
    s_cbranch_scc0 K2_ODD
    ds_read_b128 v[32:35], v10 offset:0
    ds_read_b128 v[36:39], v11 offset:0
    ds_read_b128 v[40:43], v12 offset:0
    ds_read_b128 v[44:47], v10 offset:64
    ds_read_b128 v[48:51], v11 offset:64
    ds_read_b128 v[52:55], v12 offset:64
    ds_read_b128 v[56:59], v10 offset:128
    ds_read_b128 v[60:63], v11 offset:128
    ds_read_b128 v[64:67], v12 offset:128
    ds_read_b128 v[68:71], v10 offset:192
    ds_read_b128 v[72:75], v11 offset:192
    ds_read_b128 v[76:79], v12 offset:192
    ds_read_b128 v[80:83], v10 offset:256
    ds_read_b128 v[84:87], v11 offset:256
    ds_read_b128 v[88:91], v12 offset:256
    ds_read_b128 v[92:95], v10 offset:320
    ds_read_b128 v[96:99], v11 offset:320
    ds_read_b128 v[100:103], v12 offset:320
    ds_read_b128 v[104:107], v10 offset:384
    ds_read_b128 v[108:111], v11 offset:384
    ds_read_b128 v[112:115], v12 offset:384
    ds_read_b128 v[116:119], v10 offset:448
    ds_read_b128 v[120:123], v11 offset:448
    ds_read_b128 v[124:127], v12 offset:448
    v_mfma_f32_16x16x32_bf16 v[192:195], v[32:35], v[36:39], 0
    v_mfma_f32_16x16x32_bf16 v[196:199], v[32:35], v[40:43], 0
    v_mfma_f32_16x16x32_bf16 v[192:195], v[44:47], v[48:51], v[192:195]
    v_mfma_f32_16x16x32_bf16 v[196:199], v[44:47], v[52:55], v[196:199]
    v_mfma_f32_16x16x32_bf16 v[192:195], v[56:59], v[60:63], v[192:195]
    v_mfma_f32_16x16x32_bf16 v[196:199], v[56:59], v[64:67], v[196:199]
    s_waitcnt lgkmcnt(13)
    v_mfma_f32_16x16x32_bf16 v[192:195], v[68:71], v[72:75], v[192:195]
    s_waitcnt lgkmcnt(12)
    v_mfma_f32_16x16x32_bf16 v[196:199], v[68:71], v[76:79], v[196:199]
    ds_read_b128 v[32:35], v10 offset:512
    ds_read_b128 v[36:39], v11 offset:512
    ds_read_b128 v[40:43], v12 offset:512
    ds_read_b128 v[44:47], v10 offset:576
    ds_read_b128 v[48:51], v11 offset:576
    ds_read_b128 v[52:55], v12 offset:576
    ds_read_b128 v[56:59], v10 offset:640
    ds_read_b128 v[60:63], v11 offset:640
    ds_read_b128 v[64:67], v12 offset:640
    ds_read_b128 v[68:71], v10 offset:704
    ds_read_b128 v[72:75], v11 offset:704
    ds_read_b128 v[76:79], v12 offset:704
    v_mfma_f32_16x16x32_bf16 v[192:195], v[80:83], v[84:87], v[192:195]
    v_mfma_f32_16x16x32_bf16 v[196:199], v[80:83], v[88:91], v[196:199]
    v_mfma_f32_16x16x32_bf16 v[192:195], v[92:95], v[96:99], v[192:195]
    v_mfma_f32_16x16x32_bf16 v[196:199], v[92:95], v[100:103], v[196:199]
    v_mfma_f32_16x16x32_bf16 v[192:195], v[104:107], v[108:111], v[192:195]
    v_mfma_f32_16x16x32_bf16 v[196:199], v[104:107], v[112:115], v[196:199]
    s_waitcnt lgkmcnt(13)
    v_mfma_f32_16x16x32_bf16 v[192:195], v[116:119], v[120:123], v[192:195]
    s_waitcnt lgkmcnt(12)
    v_mfma_f32_16x16x32_bf16 v[196:199], v[116:119], v[124:127], v[196:199]
    ds_read_b128 v[80:83], v10 offset:768
    ds_read_b128 v[84:87], v11 offset:768
    ds_read_b128 v[88:91], v12 offset:768
    ds_read_b128 v[92:95], v10 offset:832
    ds_read_b128 v[96:99], v11 offset:832
    ds_read_b128 v[100:103], v12 offset:832
    ds_read_b128 v[104:107], v10 offset:896
    ds_read_b128 v[108:111], v11 offset:896
    ds_read_b128 v[112:115], v12 offset:896
    ds_read_b128 v[116:119], v10 offset:960
    ds_read_b128 v[120:123], v11 offset:960
    ds_read_b128 v[124:127], v12 offset:960
    v_mfma_f32_16x16x32_bf16 v[192:195], v[32:35], v[36:39], v[192:195]
    v_mfma_f32_16x16x32_bf16 v[196:199], v[32:35], v[40:43], v[196:199]
    v_mfma_f32_16x16x32_bf16 v[192:195], v[44:47], v[48:51], v[192:195]
    v_mfma_f32_16x16x32_bf16 v[196:199], v[44:47], v[52:55], v[196:199]
    v_mfma_f32_16x16x32_bf16 v[192:195], v[56:59], v[60:63], v[192:195]
    v_mfma_f32_16x16x32_bf16 v[196:199], v[56:59], v[64:67], v[196:199]
    s_waitcnt lgkmcnt(13)
    v_mfma_f32_16x16x32_bf16 v[192:195], v[68:71], v[72:75], v[192:195]
    s_waitcnt lgkmcnt(12)
    v_mfma_f32_16x16x32_bf16 v[196:199], v[68:71], v[76:79], v[196:199]
    s_waitcnt lgkmcnt(10)
    v_mfma_f32_16x16x32_bf16 v[192:195], v[80:83], v[84:87], v[192:195]
    s_waitcnt lgkmcnt(9)
    v_mfma_f32_16x16x32_bf16 v[196:199], v[80:83], v[88:91], v[196:199]
    s_waitcnt lgkmcnt(7)
    v_mfma_f32_16x16x32_bf16 v[192:195], v[92:95], v[96:99], v[192:195]
    s_waitcnt lgkmcnt(6)
    v_mfma_f32_16x16x32_bf16 v[196:199], v[92:95], v[100:103], v[196:199]
    s_waitcnt lgkmcnt(4)
    v_mfma_f32_16x16x32_bf16 v[192:195], v[104:107], v[108:111], v[192:195]
    s_waitcnt lgkmcnt(3)
    v_mfma_f32_16x16x32_bf16 v[196:199], v[104:107], v[112:115], v[196:199]
    s_waitcnt lgkmcnt(1)
    v_mfma_f32_16x16x32_bf16 v[192:195], v[116:119], v[120:123], v[192:195]
    s_waitcnt lgkmcnt(0)
    v_mfma_f32_16x16x32_bf16 v[196:199], v[116:119], v[124:127], v[196:199]
    s_nop 5
    ds_write_b32 v236, v192
    ds_write_b32 v237, v193
    ds_write_b32 v238, v194
    ds_write_b32 v239, v195
    ds_write_b32 v250, v196
    ds_write_b32 v251, v197
    ds_write_b32 v252, v198
    ds_write_b32 v253, v199
    s_branch K2_TAB
K2_ODD:
    ds_read_b128 v[32:35], v10 offset:0
    ds_read_b128 v[36:39], v11 offset:0
    ds_read_b128 v[44:47], v10 offset:64
    ds_read_b128 v[48:51], v11 offset:64
    ds_read_b128 v[56:59], v10 offset:128
    ds_read_b128 v[60:63], v11 offset:128
    ds_read_b128 v[68:71], v10 offset:192
    ds_read_b128 v[72:75], v11 offset:192
    ds_read_b128 v[80:83], v10 offset:256
    ds_read_b128 v[84:87], v11 offset:256
    ds_read_b128 v[92:95], v10 offset:320
    ds_read_b128 v[96:99], v11 offset:320
    ds_read_b128 v[104:107], v10 offset:384
    ds_read_b128 v[108:111], v11 offset:384
    ds_read_b128 v[116:119], v10 offset:448
    ds_read_b128 v[120:123], v11 offset:448
    s_waitcnt lgkmcnt(14)
    v_mfma_f32_16x16x32_bf16 v[192:195], v[32:35], v[36:39], 0
    s_waitcnt lgkmcnt(12)
    v_mfma_f32_16x16x32_bf16 v[192:195], v[44:47], v[48:51], v[192:195]
    s_waitcnt lgkmcnt(10)
    v_mfma_f32_16x16x32_bf16 v[192:195], v[56:59], v[60:63], v[192:195]
    s_waitcnt lgkmcnt(8)
    v_mfma_f32_16x16x32_bf16 v[192:195], v[68:71], v[72:75], v[192:195]
    ds_read_b128 v[32:35], v10 offset:512
    ds_read_b128 v[36:39], v11 offset:512
    ds_read_b128 v[44:47], v10 offset:576
    ds_read_b128 v[48:51], v11 offset:576
    ds_read_b128 v[56:59], v10 offset:640
    ds_read_b128 v[60:63], v11 offset:640
    ds_read_b128 v[68:71], v10 offset:704
    ds_read_b128 v[72:75], v11 offset:704
    s_waitcnt lgkmcnt(14)
    v_mfma_f32_16x16x32_bf16 v[192:195], v[80:83], v[84:87], v[192:195]
    s_waitcnt lgkmcnt(12)
    v_mfma_f32_16x16x32_bf16 v[192:195], v[92:95], v[96:99], v[192:195]
    s_waitcnt lgkmcnt(10)
    v_mfma_f32_16x16x32_bf16 v[192:195], v[104:107], v[108:111], v[192:195]
    s_waitcnt lgkmcnt(8)
    v_mfma_f32_16x16x32_bf16 v[192:195], v[116:119], v[120:123], v[192:195]
    ds_read_b128 v[80:83], v10 offset:768
    ds_read_b128 v[84:87], v11 offset:768
    ds_read_b128 v[92:95], v10 offset:832
    ds_read_b128 v[96:99], v11 offset:832
    ds_read_b128 v[104:107], v10 offset:896
    ds_read_b128 v[108:111], v11 offset:896
    ds_read_b128 v[116:119], v10 offset:960
    ds_read_b128 v[120:123], v11 offset:960
    s_waitcnt lgkmcnt(14)
    v_mfma_f32_16x16x32_bf16 v[192:195], v[32:35], v[36:39], v[192:195]
    s_waitcnt lgkmcnt(12)
    v_mfma_f32_16x16x32_bf16 v[192:195], v[44:47], v[48:51], v[192:195]
    s_waitcnt lgkmcnt(10)
    v_mfma_f32_16x16x32_bf16 v[192:195], v[56:59], v[60:63], v[192:195]
    s_waitcnt lgkmcnt(8)
    v_mfma_f32_16x16x32_bf16 v[192:195], v[68:71], v[72:75], v[192:195]
    s_waitcnt lgkmcnt(6)
    v_mfma_f32_16x16x32_bf16 v[192:195], v[80:83], v[84:87], v[192:195]
    s_waitcnt lgkmcnt(4)
    v_mfma_f32_16x16x32_bf16 v[192:195], v[92:95], v[96:99], v[192:195]
    s_waitcnt lgkmcnt(2)
    v_mfma_f32_16x16x32_bf16 v[192:195], v[104:107], v[108:111], v[192:195]
    s_waitcnt lgkmcnt(0)
    v_mfma_f32_16x16x32_bf16 v[192:195], v[116:119], v[120:123], v[192:195]
    s_nop 7
    ds_write_b32 v236, v192
    ds_write_b32 v237, v193
    ds_write_b32 v238, v194
    ds_write_b32 v239, v195
    s_cmp_eq_u32 s3, 1
    s_cbranch_scc0 POLL_S1_D
    s_mov_b64 s[92:93], exec
    s_mov_b64 exec, 0xf
    s_mov_b32 s94, 0
    v_lshlrev_b32 v244, 6, v1
POLL_S1_L:
    global_load_dword v245, v244, s[36:37] sc0 sc1
    s_waitcnt vmcnt(0)
POLL_S1_C:
    s_add_u32 s94, s94, 1
    v_cmp_gt_u32 vcc, 56, v245
    s_cmp_gt_u32 s94, 0x40000
    s_cbranch_scc1 POLL_S1_X
    s_and_b64 vcc, vcc, exec
    s_cbranch_vccz POLL_S1_X
    s_branch POLL_S1_L
POLL_S1_X:
    s_mov_b64 exec, s[92:93]
POLL_S1_D:
K2_TAB:
    s_waitcnt lgkmcnt(0)
    s_barrier
    s_mul_i32 s54, s6, 4224
    v_lshl_add_u32 v6, v0, 4, s54
    buffer_load_dwordx4 v[200:203], v6, s[40:43], 0 offen sc1
    v_add_u32 v7, 4224, v6
    buffer_load_dwordx4 v[204:207], v7, s[40:43], 0 offen sc1
    v_lshlrev_b32 v8, 6, v0
    v_add_u32 v8, 0x1d0000, v8
    buffer_load_dwordx4 v[208:211], v8, s[40:43], 0 offen offset:0 sc1
    buffer_load_dwordx4 v[212:215], v8, s[40:43], 0 offen offset:16 sc1
    buffer_load_dwordx4 v[216:219], v8, s[40:43], 0 offen offset:32 sc1
    buffer_load_dwordx4 v[220:223], v8, s[40:43], 0 offen offset:48 sc1
    s_mov_b32 s44, s28
    s_and_b32 s45, s29, 0xffff
    s_mov_b32 s46, 0x188000
    s_mov_b32 s47, 0x20000
    v_lshrrev_b32 v246, 1, v0
    s_and_b32 s52, s4, 3
    s_mul_i32 s52, s52, 112
    v_add_u32 v246, s52, v246
    v_mul_u32_u24 v246, 3584, v246
    v_and_b32 v247, 1, v0
    v_lshl_add_u32 v246, v247, 7, v246
    s_lshl_b32 s52, s5, 8
    v_add_u32 v246, s52, v246
    v_cmp_gt_u32 vcc, 224, v0
    v_mov_b32 v247, 0x40000000
    s_nop 0
    v_cndmask_b32 v246, v247, v246, vcc
    buffer_load_dword v248, v246, s[44:47], 0 offen
    s_mov_b32 s44, s30
    s_and_b32 s45, s31, 0xffff
    s_mov_b32 s46, 0x188000
    s_mov_b32 s47, 0x20000
    buffer_load_dword v249, v246, s[44:47], 0 offen
    v_lshlrev_b32 v10, 4, v0
    ds_read_b32 v32, v224 offset:0
    ds_read_b32 v33, v225 offset:0
    ds_read_b32 v34, v226 offset:0
    ds_read_b32 v35, v227 offset:0
    ds_read_b32 v36, v228 offset:0
    ds_read_b32 v37, v229 offset:0
    ds_read_b32 v38, v230 offset:0
    ds_read_b32 v39, v231 offset:0
    ds_read_b32 v40, v232 offset:0
    ds_read_b32 v41, v233 offset:0
    ds_read_b32 v42, v234 offset:0
    ds_read_b32 v64, v224 offset:3200
    ds_read_b32 v65, v225 offset:3200
    ds_read_b32 v66, v226 offset:3200
    ds_read_b32 v67, v227 offset:3200
    ds_read_b32 v68, v228 offset:3200
    ds_read_b32 v69, v229 offset:3200
    ds_read_b32 v70, v230 offset:3200
    ds_read_b32 v71, v231 offset:3200
    ds_read_b32 v72, v232 offset:3200
    ds_read_b32 v73, v233 offset:3200
    ds_read_b32 v74, v234 offset:3200
    s_waitcnt lgkmcnt(11)
    v_cvt_pk_bf16_f32 v44, v32, v33
    v_cvt_pk_bf16_f32 v45, v34, v35
    v_cvt_pk_bf16_f32 v46, v36, v37
    v_cvt_pk_bf16_f32 v47, v38, v39
    v_cvt_pk_bf16_f32 v48, v33, v34
    v_cvt_pk_bf16_f32 v49, v35, v36
    v_cvt_pk_bf16_f32 v50, v37, v38
    v_cvt_pk_bf16_f32 v51, v39, v40
    v_cvt_pk_bf16_f32 v52, v34, v35
    v_cvt_pk_bf16_f32 v53, v36, v37
    v_cvt_pk_bf16_f32 v54, v38, v39
    v_cvt_pk_bf16_f32 v55, v40, v41
    v_cvt_pk_bf16_f32 v56, v35, v36
    v_cvt_pk_bf16_f32 v57, v37, v38
    v_cvt_pk_bf16_f32 v58, v39, v40
    v_cvt_pk_bf16_f32 v59, v41, v42
    ds_write_b128 v10, v[44:47] offset:0
    ds_write_b128 v10, v[48:51] offset:4160
    ds_write_b128 v10, v[52:55] offset:8320
    ds_write_b128 v10, v[56:59] offset:12480
    s_waitcnt lgkmcnt(0)
    v_cvt_pk_bf16_f32 v76, v64, v65
    v_cvt_pk_bf16_f32 v77, v66, v67
    v_cvt_pk_bf16_f32 v78, v68, v69
    v_cvt_pk_bf16_f32 v79, v70, v71
    v_cvt_pk_bf16_f32 v80, v65, v66
    v_cvt_pk_bf16_f32 v81, v67, v68
    v_cvt_pk_bf16_f32 v82, v69, v70
    v_cvt_pk_bf16_f32 v83, v71, v72
    v_cvt_pk_bf16_f32 v84, v66, v67
    v_cvt_pk_bf16_f32 v85, v68, v69
    v_cvt_pk_bf16_f32 v86, v70, v71
    v_cvt_pk_bf16_f32 v87, v72, v73
    v_cvt_pk_bf16_f32 v88, v67, v68
    v_cvt_pk_bf16_f32 v89, v69, v70
    v_cvt_pk_bf16_f32 v90, v71, v72
    v_cvt_pk_bf16_f32 v91, v73, v74
    ds_write_b128 v10, v[76:79] offset:16640
    ds_write_b128 v10, v[80:83] offset:20800
    ds_write_b128 v10, v[84:87] offset:24960
    ds_write_b128 v10, v[88:91] offset:29120
    v_and_b32 v11, 1, v0
    v_lshlrev_b32 v11, 4, v11
    v_lshrrev_b32 v12, 1, v0
    v_mul_u32_u24 v12, 4160, v12
    v_add_u32 v11, v11, v12
    v_add_u32 v11, 4096, v11
    v_cmp_gt_u32 vcc, 16, v0
    s_and_saveexec_b64 s[52:53], vcc
    s_cbranch_execz K2_NOTAIL
    ds_write_b128 v11, v[240:243]
K2_NOTAIL:
    s_mov_b64 exec, s[52:53]
    v_and_b32 v12, 3, v1
    v_sub_u32 v12, 3, v12
    v_mul_u32_u24 v12, 4160, v12
    v_bfe_u32 v13, v1, 2, 2
    v_lshlrev_b32 v13, 3, v13
    v_sub_u32 v12, v12, v13
    v_lshrrev_b32 v13, 4, v1
    v_lshl_add_u32 v12, v13, 4, v12
    v_mul_u32_u24 v14, 16640, v3
    v_add_u32 v12, v12, v14
    v_add_u32 v12, 24, v12
    v_and_b32 v14, 15, v1
    v_lshlrev_b32 v14, 5, v14
    v_lshl_add_u32 v14, v13, 4, v14
    v_mul_u32_u24 v9, 4576, v3
    v_add_u32 v14, v14, v9
    v_add_u32 v14, 126784, v14
    s_lshl_b32 s90, s7, 6
    v_subrev_u32 v12, s90, v12
    v_add_u32 v12, 64, v12
    v_subrev_u32 v14, s90, v14
    v_add_u32 v14, 64, v14
    v_lshrrev_b32 v227, 3, v1
    v_and_b32 v228, 7, v1
    v_bfe_u32 v229, v1, 4, 1
    v_lshlrev_b32 v229, 2, v229
    v_xor_b32 v228, v228, v229
    s_lshl_b32 s52, s3, 4
    v_add_u32 v227, s52, v227
    v_mul_u32_u24 v227, 4224, v227
    v_lshl_add_u32 v226, v228, 4, v227
    s_lshl_b32 s52, s4, 8
    s_add_u32 s52, s52, 0x200000
    v_add_u32 v226, s52, v226
    s_lshl_b32 s55, s3, 11
    s_mov_b32 s44, s28
    s_and_b32 s45, s29, 0xffff
    s_mov_b32 s46, 0x188000
    s_mov_b32 s47, 0x20000
    s_mov_b32 s48, s30
    s_and_b32 s49, s31, 0xffff
    s_mov_b32 s50, 0x188000
    s_mov_b32 s51, 0x20000
    v_lshrrev_b32 v8, 4, v1
    v_bfe_u32 v4, v1, 1, 3
    v_lshlrev_b32 v5, 1, v8
    v_sub_u32 v4, v4, v5
    v_subrev_u32 v6, 1, v4
    v_and_b32 v4, 7, v4
    v_and_b32 v6, 7, v6
    v_and_b32 v5, 1, v1
    v_lshlrev_b32 v5, 4, v5
    v_lshl_add_u32 v4, v4, 5, v5
    v_lshl_add_u32 v6, v6, 5, v5
    s_lshl_b32 s52, s3, 4
    v_add_u32 v5, s52, v8
    v_mul_u32_u24 v5, 3584, v5
    s_lshl_b32 s52, s5, 8
    v_add_u32 v5, s52, v5
    v_add_u32 v4, v4, v5
    v_add_u32 v6, v6, v5
    s_lshl_b32 s53, s3, 12
    s_waitcnt vmcnt(2)
    v_mov_b32 v15, v12
    v_mov_b32 v13, v14
    s_mov_b32 s59, 0xffff0000
    v_lshlrev_b32 v7, 4, v0
    v_add_u32 v8, 127264, v7
    v_add_u32 v9, 135936, v7
    v_mul_f32 v208, -v208, v209
    v_mul_f32 v210, -v210, v211
    v_mul_f32 v212, -v212, v213
    v_mul_f32 v214, -v214, v215
    v_mul_f32 v216, -v216, v217
    v_mul_f32 v218, -v218, v219
    v_mul_f32 v220, -v220, v221
    v_mul_f32 v222, -v222, v223
    v_lshlrev_b32 v32, 16, v200
    v_and_b32 v33, s59, v200
    v_lshlrev_b32 v34, 16, v201
    v_and_b32 v35, s59, v201
    v_lshlrev_b32 v36, 16, v202
    v_and_b32 v37, s59, v202
    v_lshlrev_b32 v38, 16, v203
    v_and_b32 v39, s59, v203
    v_fma_f32 v32, v32, v209, v208
    v_fma_f32 v33, v33, v211, v210
    v_fma_f32 v34, v34, v213, v212
    v_fma_f32 v35, v35, v215, v214
    v_fma_f32 v36, v36, v217, v216
    v_fma_f32 v37, v37, v219, v218
    v_fma_f32 v38, v38, v221, v220
    v_fma_f32 v39, v39, v223, v222
    v_cvt_pk_bf16_f32 v44, v32, v33
    v_cvt_pk_bf16_f32 v45, v34, v35
    v_cvt_pk_bf16_f32 v46, v36, v37
    v_cvt_pk_bf16_f32 v47, v38, v39
    ds_write_b128 v8, v[44:47] offset:0
    ds_write_b128 v9, v[200:203] offset:0
    v_lshlrev_b32 v32, 16, v204
    v_and_b32 v33, s59, v204
    v_lshlrev_b32 v34, 16, v205
    v_and_b32 v35, s59, v205
    v_lshlrev_b32 v36, 16, v206
    v_and_b32 v37, s59, v206
    v_lshlrev_b32 v38, 16, v207
    v_and_b32 v39, s59, v207
    v_fma_f32 v32, v32, v209, v208
    v_fma_f32 v33, v33, v211, v210
    v_fma_f32 v34, v34, v213, v212
    v_fma_f32 v35, v35, v215, v214
    v_fma_f32 v36, v36, v217, v216
    v_fma_f32 v37, v37, v219, v218
    v_fma_f32 v38, v38, v221, v220
    v_fma_f32 v39, v39, v223, v222
    v_cvt_pk_bf16_f32 v48, v32, v33
    v_cvt_pk_bf16_f32 v49, v34, v35
    v_cvt_pk_bf16_f32 v50, v36, v37
    v_cvt_pk_bf16_f32 v51, v38, v39
    ds_write_b128 v8, v[48:51] offset:4576
    ds_write_b128 v9, v[204:207] offset:4096
    v_mov_b32 v12, v15
    v_mov_b32 v14, v13
    s_waitcnt lgkmcnt(0)
    s_barrier
    ds_read_b64 v[64:65], v12 offset:3968
    ds_read_b64 v[66:67], v12 offset:3976
    ds_read_b128 v[96:99], v14 offset:384
    ds_read_b128 v[100:103], v14 offset:896
    ds_read_b128 v[104:107], v14 offset:1408
    ds_read_b128 v[108:111], v14 offset:1920
    ds_read_b128 v[112:115], v14 offset:2432
    ds_read_b128 v[116:119], v14 offset:2944
    ds_read_b128 v[120:123], v14 offset:3456
    ds_read_b128 v[124:127], v14 offset:3968
    ds_read_b64 v[68:69], v12 offset:3456
    ds_read_b64 v[70:71], v12 offset:3464
    ds_read_b64 v[72:73], v12 offset:2944
    ds_read_b64 v[74:75], v12 offset:2952
    ds_read_b64 v[76:77], v12 offset:2432
    ds_read_b64 v[78:79], v12 offset:2440
    ds_read_b64 v[80:81], v12 offset:1920
    ds_read_b64 v[82:83], v12 offset:1928
    ds_read_b64 v[84:85], v12 offset:1408
    ds_read_b64 v[86:87], v12 offset:1416
    ds_read_b64 v[88:89], v12 offset:896
    ds_read_b64 v[90:91], v12 offset:904
    ds_read_b64 v[92:93], v12 offset:384
    ds_read_b64 v[94:95], v12 offset:392
    v_mfma_f32_16x16x32_bf16 v[32:35], v[64:67], v[96:99], 0
    v_mfma_f32_16x16x32_bf16 v[36:39], v[64:67], v[100:103], 0
    v_mfma_f32_16x16x32_bf16 v[40:43], v[64:67], v[104:107], 0
    v_mfma_f32_16x16x32_bf16 v[44:47], v[64:67], v[108:111], 0
    v_mfma_f32_16x16x32_bf16 v[48:51], v[64:67], v[112:115], 0
    v_mfma_f32_16x16x32_bf16 v[52:55], v[64:67], v[116:119], 0
    v_mfma_f32_16x16x32_bf16 v[56:59], v[64:67], v[120:123], 0
    s_waitcnt lgkmcnt(14)
    v_mfma_f32_16x16x32_bf16 v[60:63], v[64:67], v[124:127], 0
    s_waitcnt lgkmcnt(12)
    v_mfma_f32_16x16x32_bf16 v[36:39], v[68:71], v[96:99], v[36:39]
    ds_read_b64 v[128:129], v12 offset:3840
    v_mfma_f32_16x16x32_bf16 v[40:43], v[68:71], v[100:103], v[40:43]
    ds_read_b64 v[130:131], v12 offset:3848
    v_mfma_f32_16x16x32_bf16 v[44:47], v[68:71], v[104:107], v[44:47]
    ds_read_b128 v[160:163], v14 offset:256
    v_mfma_f32_16x16x32_bf16 v[48:51], v[68:71], v[108:111], v[48:51]
    ds_read_b128 v[164:167], v14 offset:768
    v_mfma_f32_16x16x32_bf16 v[52:55], v[68:71], v[112:115], v[52:55]
    ds_read_b128 v[168:171], v14 offset:1280
    v_mfma_f32_16x16x32_bf16 v[56:59], v[68:71], v[116:119], v[56:59]
    ds_read_b128 v[172:175], v14 offset:1792
    v_mfma_f32_16x16x32_bf16 v[60:63], v[68:71], v[120:123], v[60:63]
    ds_read_b128 v[176:179], v14 offset:2304
    v_mfma_f32_16x16x32_bf16 v[40:43], v[72:75], v[96:99], v[40:43]
    ds_read_b128 v[180:183], v14 offset:2816
    v_mfma_f32_16x16x32_bf16 v[44:47], v[72:75], v[100:103], v[44:47]
    ds_read_b128 v[184:187], v14 offset:3328
    v_mfma_f32_16x16x32_bf16 v[48:51], v[72:75], v[104:107], v[48:51]
    ds_read_b128 v[188:191], v14 offset:3840
    v_mfma_f32_16x16x32_bf16 v[52:55], v[72:75], v[108:111], v[52:55]
    ds_read_b64 v[132:133], v12 offset:3328
    v_mfma_f32_16x16x32_bf16 v[56:59], v[72:75], v[112:115], v[56:59]
    ds_read_b64 v[134:135], v12 offset:3336
    v_mfma_f32_16x16x32_bf16 v[60:63], v[72:75], v[116:119], v[60:63]
    ds_read_b64 v[136:137], v12 offset:2816
    v_mfma_f32_16x16x32_bf16 v[44:47], v[76:79], v[96:99], v[44:47]
    ds_read_b64 v[138:139], v12 offset:2824
    v_mfma_f32_16x16x32_bf16 v[48:51], v[76:79], v[100:103], v[48:51]
    ds_read_b64 v[140:141], v12 offset:2304
    v_mfma_f32_16x16x32_bf16 v[52:55], v[76:79], v[104:107], v[52:55]
    ds_read_b64 v[142:143], v12 offset:2312
    v_mfma_f32_16x16x32_bf16 v[56:59], v[76:79], v[108:111], v[56:59]
    ds_read_b64 v[144:145], v12 offset:1792
    v_mfma_f32_16x16x32_bf16 v[60:63], v[76:79], v[112:115], v[60:63]
    ds_read_b64 v[146:147], v12 offset:1800
    v_mfma_f32_16x16x32_bf16 v[48:51], v[80:83], v[96:99], v[48:51]
    ds_read_b64 v[148:149], v12 offset:1280
    v_mfma_f32_16x16x32_bf16 v[52:55], v[80:83], v[100:103], v[52:55]
    ds_read_b64 v[150:151], v12 offset:1288
    v_mfma_f32_16x16x32_bf16 v[56:59], v[80:83], v[104:107], v[56:59]
    ds_read_b64 v[152:153], v12 offset:768
    v_mfma_f32_16x16x32_bf16 v[60:63], v[80:83], v[108:111], v[60:63]
    ds_read_b64 v[154:155], v12 offset:776
    v_mfma_f32_16x16x32_bf16 v[52:55], v[84:87], v[96:99], v[52:55]
    ds_read_b64 v[156:157], v12 offset:256
    v_mfma_f32_16x16x32_bf16 v[56:59], v[84:87], v[100:103], v[56:59]
    ds_read_b64 v[158:159], v12 offset:264
    v_mfma_f32_16x16x32_bf16 v[60:63], v[84:87], v[104:107], v[60:63]
    v_mfma_f32_16x16x32_bf16 v[56:59], v[88:91], v[96:99], v[56:59]
    v_mfma_f32_16x16x32_bf16 v[60:63], v[88:91], v[100:103], v[60:63]
    v_mfma_f32_16x16x32_bf16 v[60:63], v[92:95], v[96:99], v[60:63]
    s_waitcnt lgkmcnt(0)
    v_mfma_f32_16x16x32_bf16 v[32:35], v[128:131], v[160:163], v[32:35]
    v_mfma_f32_16x16x32_bf16 v[36:39], v[128:131], v[164:167], v[36:39]
    v_mfma_f32_16x16x32_bf16 v[40:43], v[128:131], v[168:171], v[40:43]
    v_mfma_f32_16x16x32_bf16 v[44:47], v[128:131], v[172:175], v[44:47]
    ds_read_b64 v[64:65], v12 offset:3712
    v_mfma_f32_16x16x32_bf16 v[48:51], v[128:131], v[176:179], v[48:51]
    ds_read_b64 v[66:67], v12 offset:3720
    v_mfma_f32_16x16x32_bf16 v[52:55], v[128:131], v[180:183], v[52:55]
    ds_read_b128 v[96:99], v14 offset:128
    v_mfma_f32_16x16x32_bf16 v[56:59], v[128:131], v[184:187], v[56:59]
    ds_read_b128 v[100:103], v14 offset:640
    v_mfma_f32_16x16x32_bf16 v[60:63], v[128:131], v[188:191], v[60:63]
    ds_read_b128 v[104:107], v14 offset:1152
    v_mfma_f32_16x16x32_bf16 v[36:39], v[132:135], v[160:163], v[36:39]
    ds_read_b128 v[108:111], v14 offset:1664
    v_mfma_f32_16x16x32_bf16 v[40:43], v[132:135], v[164:167], v[40:43]
    ds_read_b128 v[112:115], v14 offset:2176
    v_mfma_f32_16x16x32_bf16 v[44:47], v[132:135], v[168:171], v[44:47]
    ds_read_b128 v[116:119], v14 offset:2688
    v_mfma_f32_16x16x32_bf16 v[48:51], v[132:135], v[172:175], v[48:51]
    ds_read_b128 v[120:123], v14 offset:3200
    v_mfma_f32_16x16x32_bf16 v[52:55], v[132:135], v[176:179], v[52:55]
    ds_read_b128 v[124:127], v14 offset:3712
    v_mfma_f32_16x16x32_bf16 v[56:59], v[132:135], v[180:183], v[56:59]
    ds_read_b64 v[68:69], v12 offset:3200
    v_mfma_f32_16x16x32_bf16 v[60:63], v[132:135], v[184:187], v[60:63]
    ds_read_b64 v[70:71], v12 offset:3208
    v_mfma_f32_16x16x32_bf16 v[40:43], v[136:139], v[160:163], v[40:43]
    ds_read_b64 v[72:73], v12 offset:2688
    v_mfma_f32_16x16x32_bf16 v[44:47], v[136:139], v[164:167], v[44:47]
    ds_read_b64 v[74:75], v12 offset:2696
    v_mfma_f32_16x16x32_bf16 v[48:51], v[136:139], v[168:171], v[48:51]
    ds_read_b64 v[76:77], v12 offset:2176
    v_mfma_f32_16x16x32_bf16 v[52:55], v[136:139], v[172:175], v[52:55]
    ds_read_b64 v[78:79], v12 offset:2184
    v_mfma_f32_16x16x32_bf16 v[56:59], v[136:139], v[176:179], v[56:59]
    ds_read_b64 v[80:81], v12 offset:1664
    v_mfma_f32_16x16x32_bf16 v[60:63], v[136:139], v[180:183], v[60:63]
    ds_read_b64 v[82:83], v12 offset:1672
    v_mfma_f32_16x16x32_bf16 v[44:47], v[140:143], v[160:163], v[44:47]
    ds_read_b64 v[84:85], v12 offset:1152
    v_mfma_f32_16x16x32_bf16 v[48:51], v[140:143], v[164:167], v[48:51]
    ds_read_b64 v[86:87], v12 offset:1160
    v_mfma_f32_16x16x32_bf16 v[52:55], v[140:143], v[168:171], v[52:55]
    ds_read_b64 v[88:89], v12 offset:640
    v_mfma_f32_16x16x32_bf16 v[56:59], v[140:143], v[172:175], v[56:59]
    ds_read_b64 v[90:91], v12 offset:648
    v_mfma_f32_16x16x32_bf16 v[60:63], v[140:143], v[176:179], v[60:63]
    ds_read_b64 v[92:93], v12 offset:128
    v_mfma_f32_16x16x32_bf16 v[48:51], v[144:147], v[160:163], v[48:51]
    ds_read_b64 v[94:95], v12 offset:136
    v_mfma_f32_16x16x32_bf16 v[52:55], v[144:147], v[164:167], v[52:55]
    v_mfma_f32_16x16x32_bf16 v[56:59], v[144:147], v[168:171], v[56:59]
    v_mfma_f32_16x16x32_bf16 v[60:63], v[144:147], v[172:175], v[60:63]
    v_mfma_f32_16x16x32_bf16 v[52:55], v[148:151], v[160:163], v[52:55]
    v_mfma_f32_16x16x32_bf16 v[56:59], v[148:151], v[164:167], v[56:59]
    v_mfma_f32_16x16x32_bf16 v[60:63], v[148:151], v[168:171], v[60:63]
    v_mfma_f32_16x16x32_bf16 v[56:59], v[152:155], v[160:163], v[56:59]
    v_mfma_f32_16x16x32_bf16 v[60:63], v[152:155], v[164:167], v[60:63]
    v_mfma_f32_16x16x32_bf16 v[60:63], v[156:159], v[160:163], v[60:63]
    s_waitcnt lgkmcnt(0)
    v_mfma_f32_16x16x32_bf16 v[32:35], v[64:67], v[96:99], v[32:35]
    v_mfma_f32_16x16x32_bf16 v[36:39], v[64:67], v[100:103], v[36:39]
    v_mfma_f32_16x16x32_bf16 v[40:43], v[64:67], v[104:107], v[40:43]
    v_mfma_f32_16x16x32_bf16 v[44:47], v[64:67], v[108:111], v[44:47]
    ds_read_b64 v[128:129], v12 offset:3584
    v_mfma_f32_16x16x32_bf16 v[48:51], v[64:67], v[112:115], v[48:51]
    ds_read_b64 v[130:131], v12 offset:3592
    v_mfma_f32_16x16x32_bf16 v[52:55], v[64:67], v[116:119], v[52:55]
    ds_read_b128 v[160:163], v14 offset:0
    v_mfma_f32_16x16x32_bf16 v[56:59], v[64:67], v[120:123], v[56:59]
    ds_read_b128 v[164:167], v14 offset:512
    v_mfma_f32_16x16x32_bf16 v[60:63], v[64:67], v[124:127], v[60:63]
    ds_read_b128 v[168:171], v14 offset:1024
    v_mfma_f32_16x16x32_bf16 v[36:39], v[68:71], v[96:99], v[36:39]
    ds_read_b128 v[172:175], v14 offset:1536
    v_mfma_f32_16x16x32_bf16 v[40:43], v[68:71], v[100:103], v[40:43]
    ds_read_b128 v[176:179], v14 offset:2048
    v_mfma_f32_16x16x32_bf16 v[44:47], v[68:71], v[104:107], v[44:47]
    ds_read_b128 v[180:183], v14 offset:2560
    v_mfma_f32_16x16x32_bf16 v[48:51], v[68:71], v[108:111], v[48:51]
    ds_read_b128 v[184:187], v14 offset:3072
    v_mfma_f32_16x16x32_bf16 v[52:55], v[68:71], v[112:115], v[52:55]
    ds_read_b128 v[188:191], v14 offset:3584
    v_mfma_f32_16x16x32_bf16 v[56:59], v[68:71], v[116:119], v[56:59]
    ds_read_b64 v[132:133], v12 offset:3072
    v_mfma_f32_16x16x32_bf16 v[60:63], v[68:71], v[120:123], v[60:63]
    ds_read_b64 v[134:135], v12 offset:3080
    v_mfma_f32_16x16x32_bf16 v[40:43], v[72:75], v[96:99], v[40:43]
    ds_read_b64 v[136:137], v12 offset:2560
    v_mfma_f32_16x16x32_bf16 v[44:47], v[72:75], v[100:103], v[44:47]
    ds_read_b64 v[138:139], v12 offset:2568
    v_mfma_f32_16x16x32_bf16 v[48:51], v[72:75], v[104:107], v[48:51]
    ds_read_b64 v[140:141], v12 offset:2048
    v_mfma_f32_16x16x32_bf16 v[52:55], v[72:75], v[108:111], v[52:55]
    ds_read_b64 v[142:143], v12 offset:2056
    v_mfma_f32_16x16x32_bf16 v[56:59], v[72:75], v[112:115], v[56:59]
    ds_read_b64 v[144:145], v12 offset:1536
    v_mfma_f32_16x16x32_bf16 v[60:63], v[72:75], v[116:119], v[60:63]
    ds_read_b64 v[146:147], v12 offset:1544
    v_mfma_f32_16x16x32_bf16 v[44:47], v[76:79], v[96:99], v[44:47]
    ds_read_b64 v[148:149], v12 offset:1024
    v_mfma_f32_16x16x32_bf16 v[48:51], v[76:79], v[100:103], v[48:51]
    ds_read_b64 v[150:151], v12 offset:1032
    v_mfma_f32_16x16x32_bf16 v[52:55], v[76:79], v[104:107], v[52:55]
    ds_read_b64 v[152:153], v12 offset:512
    v_mfma_f32_16x16x32_bf16 v[56:59], v[76:79], v[108:111], v[56:59]
    ds_read_b64 v[154:155], v12 offset:520
    v_mfma_f32_16x16x32_bf16 v[60:63], v[76:79], v[112:115], v[60:63]
    ds_read_b64 v[156:157], v12 offset:0
    v_mfma_f32_16x16x32_bf16 v[48:51], v[80:83], v[96:99], v[48:51]
    ds_read_b64 v[158:159], v12 offset:8
    v_mfma_f32_16x16x32_bf16 v[52:55], v[80:83], v[100:103], v[52:55]
    v_mfma_f32_16x16x32_bf16 v[56:59], v[80:83], v[104:107], v[56:59]
    v_mfma_f32_16x16x32_bf16 v[60:63], v[80:83], v[108:111], v[60:63]
    v_mfma_f32_16x16x32_bf16 v[52:55], v[84:87], v[96:99], v[52:55]
    v_mfma_f32_16x16x32_bf16 v[56:59], v[84:87], v[100:103], v[56:59]
    v_mfma_f32_16x16x32_bf16 v[60:63], v[84:87], v[104:107], v[60:63]
    v_mfma_f32_16x16x32_bf16 v[56:59], v[88:91], v[96:99], v[56:59]
    v_mfma_f32_16x16x32_bf16 v[60:63], v[88:91], v[100:103], v[60:63]
    v_mfma_f32_16x16x32_bf16 v[60:63], v[92:95], v[96:99], v[60:63]
    s_waitcnt lgkmcnt(0)
    v_mfma_f32_16x16x32_bf16 v[32:35], v[128:131], v[160:163], v[32:35]
    v_mfma_f32_16x16x32_bf16 v[36:39], v[128:131], v[164:167], v[36:39]
    v_mfma_f32_16x16x32_bf16 v[40:43], v[128:131], v[168:171], v[40:43]
    v_mfma_f32_16x16x32_bf16 v[44:47], v[128:131], v[172:175], v[44:47]
    v_mfma_f32_16x16x32_bf16 v[48:51], v[128:131], v[176:179], v[48:51]
    v_mfma_f32_16x16x32_bf16 v[52:55], v[128:131], v[180:183], v[52:55]
    v_mfma_f32_16x16x32_bf16 v[56:59], v[128:131], v[184:187], v[56:59]
    v_mfma_f32_16x16x32_bf16 v[60:63], v[128:131], v[188:191], v[60:63]
    v_mfma_f32_16x16x32_bf16 v[36:39], v[132:135], v[160:163], v[36:39]
    v_mfma_f32_16x16x32_bf16 v[40:43], v[132:135], v[164:167], v[40:43]
    v_mfma_f32_16x16x32_bf16 v[44:47], v[132:135], v[168:171], v[44:47]
    v_mfma_f32_16x16x32_bf16 v[48:51], v[132:135], v[172:175], v[48:51]
    v_mfma_f32_16x16x32_bf16 v[52:55], v[132:135], v[176:179], v[52:55]
    v_mfma_f32_16x16x32_bf16 v[56:59], v[132:135], v[180:183], v[56:59]
    v_mfma_f32_16x16x32_bf16 v[60:63], v[132:135], v[184:187], v[60:63]
    v_mfma_f32_16x16x32_bf16 v[40:43], v[136:139], v[160:163], v[40:43]
    v_mfma_f32_16x16x32_bf16 v[44:47], v[136:139], v[164:167], v[44:47]
    v_mfma_f32_16x16x32_bf16 v[48:51], v[136:139], v[168:171], v[48:51]
    v_mfma_f32_16x16x32_bf16 v[52:55], v[136:139], v[172:175], v[52:55]
    v_mfma_f32_16x16x32_bf16 v[56:59], v[136:139], v[176:179], v[56:59]
    v_mfma_f32_16x16x32_bf16 v[60:63], v[136:139], v[180:183], v[60:63]
    v_mfma_f32_16x16x32_bf16 v[44:47], v[140:143], v[160:163], v[44:47]
    v_mfma_f32_16x16x32_bf16 v[48:51], v[140:143], v[164:167], v[48:51]
    v_mfma_f32_16x16x32_bf16 v[52:55], v[140:143], v[168:171], v[52:55]
    v_mfma_f32_16x16x32_bf16 v[56:59], v[140:143], v[172:175], v[56:59]
    v_mfma_f32_16x16x32_bf16 v[60:63], v[140:143], v[176:179], v[60:63]
    v_mfma_f32_16x16x32_bf16 v[48:51], v[144:147], v[160:163], v[48:51]
    v_mfma_f32_16x16x32_bf16 v[52:55], v[144:147], v[164:167], v[52:55]
    v_mfma_f32_16x16x32_bf16 v[56:59], v[144:147], v[168:171], v[56:59]
    v_mfma_f32_16x16x32_bf16 v[60:63], v[144:147], v[172:175], v[60:63]
    v_mfma_f32_16x16x32_bf16 v[52:55], v[148:151], v[160:163], v[52:55]
    v_mfma_f32_16x16x32_bf16 v[56:59], v[148:151], v[164:167], v[56:59]
    v_mfma_f32_16x16x32_bf16 v[60:63], v[148:151], v[168:171], v[60:63]
    v_mfma_f32_16x16x32_bf16 v[56:59], v[152:155], v[160:163], v[56:59]
    v_mfma_f32_16x16x32_bf16 v[60:63], v[152:155], v[164:167], v[60:63]
    v_mfma_f32_16x16x32_bf16 v[60:63], v[156:159], v[160:163], v[60:63]
    v_lshlrev_b32 v10, 4, v1
    s_lshl_b32 s91, s3, 12
    s_add_u32 s91, s91, 98816
    v_add_u32 v10, s91, v10
    s_xor_b32 s92, s3, 1
    s_lshl_b32 s92, s92, 12
    s_add_u32 s92, s92, 98816
    v_lshlrev_b32 v11, 4, v1
    v_add_u32 v11, s92, v11
    s_cmp_eq_u32 s7, 0
    s_cbranch_scc0 K2_RODD
    ds_write_b128 v10, v[48:51] offset:0
    ds_write_b128 v10, v[52:55] offset:1024
    ds_write_b128 v10, v[56:59] offset:2048
    ds_write_b128 v10, v[60:63] offset:3072
    s_branch K2_RJOIN
K2_RODD:
    ds_write_b128 v10, v[32:35] offset:0
    ds_write_b128 v10, v[36:39] offset:1024
    ds_write_b128 v10, v[40:43] offset:2048
    ds_write_b128 v10, v[44:47] offset:3072
    v_mov_b32 v32, v48
    v_mov_b32 v33, v49
    v_mov_b32 v34, v50
    v_mov_b32 v35, v51
    v_mov_b32 v36, v52
    v_mov_b32 v37, v53
    v_mov_b32 v38, v54
    v_mov_b32 v39, v55
    v_mov_b32 v40, v56
    v_mov_b32 v41, v57
    v_mov_b32 v42, v58
    v_mov_b32 v43, v59
    v_mov_b32 v44, v60
    v_mov_b32 v45, v61
    v_mov_b32 v46, v62
    v_mov_b32 v47, v63
K2_RJOIN:
    v_and_b32 v12, 15, v1
    v_lshlrev_b32 v12, 5, v12
    v_lshrrev_b32 v13, 4, v1
    v_lshl_add_u32 v12, v13, 3, v12
    s_lshl_b32 s90, s7, 11
    v_add_u32 v12, s90, v12
    v_mul_u32_u24 v13, 4576, v3
    v_add_u32 v13, v13, v12
    v_add_u32 v13, 127264, v13
    v_mul_u32_u24 v14, 4096, v3
    v_add_u32 v14, v14, v12
    v_add_u32 v14, 135936, v14
    v_add_u32 v9, s6, v3
    v_mul_u32_u24 v9, 4224, v9
    v_lshl_add_u32 v9, v1, 4, v9
    v_add_u32 v9, s90, v9
    v_add_u32 v9, 0x200000, v9
    v_subrev_u32 v15, s90, v12
    s_lshl_b32 s91, s3, 11
    s_add_u32 s91, s91, 115200
    v_add_u32 v15, s91, v15
    v_lshl_add_u32 v16, v1, 4, s91
    s_waitcnt lgkmcnt(0)
    s_barrier
    ds_read_b128 v[64:67], v11 offset:0
    ds_read_b128 v[68:71], v11 offset:1024
    ds_read_b128 v[72:75], v11 offset:2048
    ds_read_b128 v[76:79], v11 offset:3072
    ds_read_b64 v[80:81], v13 offset:0
    ds_read_b64 v[88:89], v14 offset:0
    ds_read_b64 v[82:83], v13 offset:512
    ds_read_b64 v[90:91], v14 offset:512
    ds_read_b64 v[84:85], v13 offset:1024
    ds_read_b64 v[92:93], v14 offset:1024
    ds_read_b64 v[86:87], v13 offset:1536
    ds_read_b64 v[94:95], v14 offset:1536
    s_waitcnt lgkmcnt(0)
    v_add_f32 v32, v32, v64
    v_add_f32 v33, v33, v65
    v_add_f32 v34, v34, v66
    v_add_f32 v35, v35, v67
    v_lshlrev_b32 v96, 16, v80
    v_and_b32 v97, s59, v80
    v_lshlrev_b32 v100, 16, v88
    v_and_b32 v101, s59, v88
    v_lshlrev_b32 v98, 16, v81
    v_and_b32 v99, s59, v81
    v_lshlrev_b32 v102, 16, v89
    v_and_b32 v103, s59, v89
    v_fma_f32 v32, v96, s58, v32
    v_fma_f32 v33, v97, s58, v33
    v_fma_f32 v34, v98, s58, v34
    v_fma_f32 v35, v99, s58, v35
    v_add_f32 v32, v32, v100
    v_add_f32 v33, v33, v101
    v_add_f32 v34, v34, v102
    v_add_f32 v35, v35, v103
    v_cvt_pk_bf16_f32 v106, v32, v33
    v_cvt_pk_bf16_f32 v107, v34, v35
    ds_write_b64 v15, v[106:107] offset:0
    v_add_f32 v36, v36, v68
    v_add_f32 v37, v37, v69
    v_add_f32 v38, v38, v70
    v_add_f32 v39, v39, v71
    v_lshlrev_b32 v96, 16, v82
    v_and_b32 v97, s59, v82
    v_lshlrev_b32 v100, 16, v90
    v_and_b32 v101, s59, v90
    v_lshlrev_b32 v98, 16, v83
    v_and_b32 v99, s59, v83
    v_lshlrev_b32 v102, 16, v91
    v_and_b32 v103, s59, v91
    v_fma_f32 v36, v96, s58, v36
    v_fma_f32 v37, v97, s58, v37
    v_fma_f32 v38, v98, s58, v38
    v_fma_f32 v39, v99, s58, v39
    v_add_f32 v36, v36, v100
    v_add_f32 v37, v37, v101
    v_add_f32 v38, v38, v102
    v_add_f32 v39, v39, v103
    v_cvt_pk_bf16_f32 v108, v36, v37
    v_cvt_pk_bf16_f32 v109, v38, v39
    ds_write_b64 v15, v[108:109] offset:512
    v_add_f32 v40, v40, v72
    v_add_f32 v41, v41, v73
    v_add_f32 v42, v42, v74
    v_add_f32 v43, v43, v75
    v_lshlrev_b32 v96, 16, v84
    v_and_b32 v97, s59, v84
    v_lshlrev_b32 v100, 16, v92
    v_and_b32 v101, s59, v92
    v_lshlrev_b32 v98, 16, v85
    v_and_b32 v99, s59, v85
    v_lshlrev_b32 v102, 16, v93
    v_and_b32 v103, s59, v93
    v_fma_f32 v40, v96, s58, v40
    v_fma_f32 v41, v97, s58, v41
    v_fma_f32 v42, v98, s58, v42
    v_fma_f32 v43, v99, s58, v43
    v_add_f32 v40, v40, v100
    v_add_f32 v41, v41, v101
    v_add_f32 v42, v42, v102
    v_add_f32 v43, v43, v103
    v_cvt_pk_bf16_f32 v106, v40, v41
    v_cvt_pk_bf16_f32 v107, v42, v43
    ds_write_b64 v15, v[106:107] offset:1024
    v_add_f32 v44, v44, v76
    v_add_f32 v45, v45, v77
    v_add_f32 v46, v46, v78
    v_add_f32 v47, v47, v79
    v_lshlrev_b32 v96, 16, v86
    v_and_b32 v97, s59, v86
    v_lshlrev_b32 v100, 16, v94
    v_and_b32 v101, s59, v94
    v_lshlrev_b32 v98, 16, v87
    v_and_b32 v99, s59, v87
    v_lshlrev_b32 v102, 16, v95
    v_and_b32 v103, s59, v95
    v_fma_f32 v44, v96, s58, v44
    v_fma_f32 v45, v97, s58, v45
    v_fma_f32 v46, v98, s58, v46
    v_fma_f32 v47, v99, s58, v47
    v_add_f32 v44, v44, v100
    v_add_f32 v45, v45, v101
    v_add_f32 v46, v46, v102
    v_add_f32 v47, v47, v103
    v_cvt_pk_bf16_f32 v108, v44, v45
    v_cvt_pk_bf16_f32 v109, v46, v47
    ds_write_b64 v15, v[108:109] offset:1536
    s_waitcnt lgkmcnt(0)
    ds_read_b128 v[64:67], v16
    ds_read_b128 v[68:71], v16 offset:1024
    s_waitcnt lgkmcnt(0)
    buffer_store_dwordx4 v[64:67], v9, s[40:43], 0 offen sc0 sc1
    buffer_store_dwordx4 v[68:71], v9, s[40:43], 0 offen offset:1024 sc0 sc1
    s_barrier
    s_add_u32 m0, s53, 33280
    s_mov_b32 s52, 0
    buffer_load_dwordx4 v4, s[44:47], s52 offen offset:0 lds
    s_mov_b32 s52, 13312
    buffer_load_dwordx4 v4, s[44:47], s52 offen offset:1024 lds
    s_mov_b32 s52, 26624
    buffer_load_dwordx4 v4, s[44:47], s52 offen offset:2048 lds
    s_mov_b32 s52, 39936
    buffer_load_dwordx4 v4, s[44:47], s52 offen offset:3072 lds
    s_add_u32 m0, s53, 49664
    s_mov_b32 s52, 0
    buffer_load_dwordx4 v6, s[48:51], s52 offen offset:0 lds
    s_mov_b32 s52, 13312
    buffer_load_dwordx4 v6, s[48:51], s52 offen offset:1024 lds
    s_mov_b32 s52, 26624
    buffer_load_dwordx4 v6, s[48:51], s52 offen offset:2048 lds
    s_mov_b32 s52, 39936
    buffer_load_dwordx4 v6, s[48:51], s52 offen offset:3072 lds
    s_waitcnt vmcnt(8)
    s_barrier
    s_cmp_eq_u32 s3, 0
    s_cbranch_scc0 ARR_S2
    s_mov_b64 s[92:93], exec
    s_mov_b64 exec, 1
    s_and_b32 s94, s2, 15
    s_lshl_b32 s94, s94, 8
    s_add_u32 s94, s94, 0x1e0000
    v_mov_b32 v244, s94
    v_mov_b32 v245, 1
    global_atomic_add v244, v245, s[38:39] sc1
    s_mov_b64 exec, s[92:93]
ARR_S2:
    s_add_u32 m0, s53, 66048
    s_mov_b32 s52, 229376
    buffer_load_dwordx4 v4, s[44:47], s52 offen offset:0 lds
    v_bfe_u32 v5, v1, 4, 1
    v_bfe_u32 v3, v1, 2, 2
    v_lshrrev_b32 v7, 5, v1
    v_lshl_add_u32 v7, v7, 3, v3
    s_mov_b32 s52, 242688
    buffer_load_dwordx4 v4, s[44:47], s52 offen offset:1024 lds
    v_lshlrev_b32 v7, 8, v7
    v_lshl_add_u32 v7, v5, 14, v7
    v_and_b32 v8, 3, v1
    v_lshl_add_u32 v7, v8, 3, v7
    s_mov_b32 s52, 256000
    buffer_load_dwordx4 v4, s[44:47], s52 offen offset:2048 lds
    v_lshl_add_u32 v3, v3, 1, v5
    s_lshl_b32 s54, s3, 1
    v_add_u32 v3, s54, v3
    v_add_u32 v8, 1, v3
    s_mov_b32 s52, 269312
    buffer_load_dwordx4 v4, s[44:47], s52 offen offset:3072 lds
    v_and_b32 v3, 7, v3
    v_and_b32 v8, 7, v8
    v_lshl_add_u32 v8, v8, 5, v7
    v_lshl_add_u32 v7, v3, 5, v7
    s_add_u32 m0, s53, 82432
    s_mov_b32 s52, 229376
    buffer_load_dwordx4 v6, s[48:51], s52 offen offset:0 lds
    v_add_u32 v7, 33280, v7
    v_add_u32 v8, 33280, v8
    v_mov_b32 v10, 0x3f803f80
    v_accvgpr_write_b32 a232, v10
    s_mov_b32 s52, 242688
    buffer_load_dwordx4 v6, s[48:51], s52 offen offset:1024 lds
    v_accvgpr_write_b32 a233, v10
    v_accvgpr_write_b32 a234, v10
    v_accvgpr_write_b32 a235, v10
    v_lshrrev_b32 v9, 4, v1
    s_mov_b32 s52, 256000
    buffer_load_dwordx4 v6, s[48:51], s52 offen offset:2048 lds
    v_and_b32 v9, 1, v9
    v_and_b32 v11, 15, v1
    v_cmp_eq_u32 vcc, v9, v11
    s_nop 1
    v_cndmask_b32 v10, 0, v10, vcc
    s_mov_b32 s52, 269312
    buffer_load_dwordx4 v6, s[48:51], s52 offen offset:3072 lds
    v_accvgpr_write_b32 a236, v10
    v_accvgpr_write_b32 a237, v10
    v_accvgpr_write_b32 a238, v10
    v_accvgpr_write_b32 a239, v10
    s_waitcnt vmcnt(8)
    s_barrier
    ds_read_b64_tr_b16 a[0:1], v7 offset:0
    ds_read_b64_tr_b16 a[2:3], v7 offset:1024
    ds_read_b64_tr_b16 a[4:5], v7 offset:4096
    ds_read_b64_tr_b16 a[6:7], v7 offset:5120
    ds_read_b64_tr_b16 a[8:9], v7 offset:8192
    ds_read_b64_tr_b16 a[10:11], v7 offset:9216
    ds_read_b64_tr_b16 a[12:13], v7 offset:12288
    ds_read_b64_tr_b16 a[14:15], v7 offset:13312
    ds_read_b64_tr_b16 a[112:113], v8 offset:0
    ds_read_b64_tr_b16 a[114:115], v8 offset:1024
    ds_read_b64_tr_b16 a[116:117], v8 offset:4096
    ds_read_b64_tr_b16 a[118:119], v8 offset:5120
    ds_read_b64_tr_b16 a[120:121], v8 offset:8192
    ds_read_b64_tr_b16 a[122:123], v8 offset:9216
    ds_read_b64_tr_b16 a[124:125], v8 offset:12288
    ds_read_b64_tr_b16 a[126:127], v8 offset:13312
    v_add_u32 v7, 0x8000, v7
    v_add_u32 v8, 0x8000, v8
    s_add_u32 m0, s53, 0
    s_mov_b32 s52, 458752
    buffer_load_dwordx4 v4, s[44:47], s52 offen offset:0 lds
    s_mov_b32 s52, 472064
    buffer_load_dwordx4 v4, s[44:47], s52 offen offset:1024 lds
    s_mov_b32 s52, 485376
    buffer_load_dwordx4 v4, s[44:47], s52 offen offset:2048 lds
    s_mov_b32 s52, 498688
    buffer_load_dwordx4 v4, s[44:47], s52 offen offset:3072 lds
    s_add_u32 m0, s53, 16384
    s_mov_b32 s52, 458752
    buffer_load_dwordx4 v6, s[48:51], s52 offen offset:0 lds
    s_mov_b32 s52, 472064
    buffer_load_dwordx4 v6, s[48:51], s52 offen offset:1024 lds
    s_mov_b32 s52, 485376
    buffer_load_dwordx4 v6, s[48:51], s52 offen offset:2048 lds
    s_mov_b32 s52, 498688
    buffer_load_dwordx4 v6, s[48:51], s52 offen offset:3072 lds
    s_waitcnt lgkmcnt(0)
    s_waitcnt vmcnt(8)
    s_barrier
    ds_read_b64_tr_b16 a[16:17], v7 offset:0
    ds_read_b64_tr_b16 a[18:19], v7 offset:1024
    ds_read_b64_tr_b16 a[20:21], v7 offset:4096
    ds_read_b64_tr_b16 a[22:23], v7 offset:5120
    ds_read_b64_tr_b16 a[24:25], v7 offset:8192
    ds_read_b64_tr_b16 a[26:27], v7 offset:9216
    ds_read_b64_tr_b16 a[28:29], v7 offset:12288
    ds_read_b64_tr_b16 a[30:31], v7 offset:13312
    ds_read_b64_tr_b16 a[128:129], v8 offset:0
    ds_read_b64_tr_b16 a[130:131], v8 offset:1024
    ds_read_b64_tr_b16 a[132:133], v8 offset:4096
    ds_read_b64_tr_b16 a[134:135], v8 offset:5120
    ds_read_b64_tr_b16 a[136:137], v8 offset:8192
    ds_read_b64_tr_b16 a[138:139], v8 offset:9216
    ds_read_b64_tr_b16 a[140:141], v8 offset:12288
    ds_read_b64_tr_b16 a[142:143], v8 offset:13312
    v_add_u32 v7, 0xfffefe00, v7
    v_add_u32 v8, 0xfffefe00, v8
    s_add_u32 m0, s53, 33280
    s_mov_b32 s52, 688128
    buffer_load_dwordx4 v4, s[44:47], s52 offen offset:0 lds
    v_mfma_f32_16x16x32_bf16 v[188:191], a[236:239], a[0:3], 0
    s_mov_b32 s52, 701440
    buffer_load_dwordx4 v4, s[44:47], s52 offen offset:1024 lds
    v_mfma_f32_16x16x32_bf16 v[188:191], a[236:239], a[4:7], v[188:191]
    s_mov_b32 s52, 714752
    buffer_load_dwordx4 v4, s[44:47], s52 offen offset:2048 lds
    v_mfma_f32_16x16x32_bf16 v[188:191], a[236:239], a[8:11], v[188:191]
    s_mov_b32 s52, 728064
    buffer_load_dwordx4 v4, s[44:47], s52 offen offset:3072 lds
    v_mfma_f32_16x16x32_bf16 v[188:191], a[236:239], a[12:15], v[188:191]
    s_add_u32 m0, s53, 49664
    s_mov_b32 s52, 688128
    buffer_load_dwordx4 v6, s[48:51], s52 offen offset:0 lds
    v_mfma_f32_16x16x32_bf16 v[204:207], a[236:239], a[112:115], 0
    s_mov_b32 s52, 701440
    buffer_load_dwordx4 v6, s[48:51], s52 offen offset:1024 lds
    v_mfma_f32_16x16x32_bf16 v[204:207], a[236:239], a[116:119], v[204:207]
    s_mov_b32 s52, 714752
    buffer_load_dwordx4 v6, s[48:51], s52 offen offset:2048 lds
    v_mfma_f32_16x16x32_bf16 v[204:207], a[236:239], a[120:123], v[204:207]
    s_mov_b32 s52, 728064
    buffer_load_dwordx4 v6, s[48:51], s52 offen offset:3072 lds
    v_mfma_f32_16x16x32_bf16 v[204:207], a[236:239], a[124:127], v[204:207]
    s_waitcnt lgkmcnt(0)
    s_waitcnt vmcnt(8)
    s_barrier
    ds_read_b64_tr_b16 a[32:33], v7 offset:0
    ds_read_b64_tr_b16 a[34:35], v7 offset:1024
    ds_read_b64_tr_b16 a[36:37], v7 offset:4096
    ds_read_b64_tr_b16 a[38:39], v7 offset:5120
    ds_read_b64_tr_b16 a[40:41], v7 offset:8192
    ds_read_b64_tr_b16 a[42:43], v7 offset:9216
    ds_read_b64_tr_b16 a[44:45], v7 offset:12288
    ds_read_b64_tr_b16 a[46:47], v7 offset:13312
    ds_read_b64_tr_b16 a[144:145], v8 offset:0
    ds_read_b64_tr_b16 a[146:147], v8 offset:1024
    ds_read_b64_tr_b16 a[148:149], v8 offset:4096
    ds_read_b64_tr_b16 a[150:151], v8 offset:5120
    ds_read_b64_tr_b16 a[152:153], v8 offset:8192
    ds_read_b64_tr_b16 a[154:155], v8 offset:9216
    ds_read_b64_tr_b16 a[156:157], v8 offset:12288
    ds_read_b64_tr_b16 a[158:159], v8 offset:13312
    v_add_u32 v7, 0x8200, v7
    v_add_u32 v8, 0x8200, v8
    s_add_u32 m0, s53, 66048
    s_mov_b32 s52, 917504
    buffer_load_dwordx4 v4, s[44:47], s52 offen offset:0 lds
    v_mfma_f32_16x16x32_bf16 v[188:191], a[236:239], a[16:19], v[188:191]
    s_mov_b32 s52, 930816
    buffer_load_dwordx4 v4, s[44:47], s52 offen offset:1024 lds
    v_mfma_f32_16x16x32_bf16 v[188:191], a[236:239], a[20:23], v[188:191]
    s_mov_b32 s52, 944128
    buffer_load_dwordx4 v4, s[44:47], s52 offen offset:2048 lds
    v_mfma_f32_16x16x32_bf16 v[188:191], a[236:239], a[24:27], v[188:191]
    s_mov_b32 s52, 957440
    buffer_load_dwordx4 v4, s[44:47], s52 offen offset:3072 lds
    v_mfma_f32_16x16x32_bf16 v[188:191], a[236:239], a[28:31], v[188:191]
    s_add_u32 m0, s53, 82432
    s_mov_b32 s52, 917504
    buffer_load_dwordx4 v6, s[48:51], s52 offen offset:0 lds
    v_mfma_f32_16x16x32_bf16 v[204:207], a[236:239], a[128:131], v[204:207]
    s_mov_b32 s52, 930816
    buffer_load_dwordx4 v6, s[48:51], s52 offen offset:1024 lds
    v_mfma_f32_16x16x32_bf16 v[204:207], a[236:239], a[132:135], v[204:207]
    s_mov_b32 s52, 944128
    buffer_load_dwordx4 v6, s[48:51], s52 offen offset:2048 lds
    v_mfma_f32_16x16x32_bf16 v[204:207], a[236:239], a[136:139], v[204:207]
    s_mov_b32 s52, 957440
    buffer_load_dwordx4 v6, s[48:51], s52 offen offset:3072 lds
    v_mfma_f32_16x16x32_bf16 v[204:207], a[236:239], a[140:143], v[204:207]
    s_waitcnt lgkmcnt(0)
    s_waitcnt vmcnt(8)
    s_barrier
    ds_read_b64_tr_b16 a[48:49], v7 offset:0
    ds_read_b64_tr_b16 a[50:51], v7 offset:1024
    ds_read_b64_tr_b16 a[52:53], v7 offset:4096
    ds_read_b64_tr_b16 a[54:55], v7 offset:5120
    ds_read_b64_tr_b16 a[56:57], v7 offset:8192
    ds_read_b64_tr_b16 a[58:59], v7 offset:9216
    ds_read_b64_tr_b16 a[60:61], v7 offset:12288
    ds_read_b64_tr_b16 a[62:63], v7 offset:13312
    ds_read_b64_tr_b16 a[160:161], v8 offset:0
    ds_read_b64_tr_b16 a[162:163], v8 offset:1024
    ds_read_b64_tr_b16 a[164:165], v8 offset:4096
    ds_read_b64_tr_b16 a[166:167], v8 offset:5120
    ds_read_b64_tr_b16 a[168:169], v8 offset:8192
    ds_read_b64_tr_b16 a[170:171], v8 offset:9216
    ds_read_b64_tr_b16 a[172:173], v8 offset:12288
    ds_read_b64_tr_b16 a[174:175], v8 offset:13312
    v_add_u32 v7, 0x8000, v7
    v_add_u32 v8, 0x8000, v8
    s_cmp_eq_u32 s3, 0
    s_cbranch_scc0 PS_2132
    s_mov_b64 s[92:93], exec
    s_mov_b64 exec, 0xffff
    v_lshlrev_b32 v244, 8, v1
    v_add_u32 v244, 0x1e0000, v244
    global_load_dword v245, v244, s[38:39] sc0 sc1
    s_mov_b64 exec, s[92:93]
PS_2132:
    s_add_u32 m0, s53, 0
    s_mov_b32 s52, 1146880
    buffer_load_dwordx4 v4, s[44:47], s52 offen offset:0 lds
    v_mfma_f32_16x16x32_bf16 v[188:191], a[236:239], a[32:35], v[188:191]
    s_mov_b32 s52, 1160192
    buffer_load_dwordx4 v4, s[44:47], s52 offen offset:1024 lds
    v_mfma_f32_16x16x32_bf16 v[188:191], a[236:239], a[36:39], v[188:191]
    s_mov_b32 s52, 1173504
    buffer_load_dwordx4 v4, s[44:47], s52 offen offset:2048 lds
    v_mfma_f32_16x16x32_bf16 v[188:191], a[236:239], a[40:43], v[188:191]
    s_mov_b32 s52, 1186816
    buffer_load_dwordx4 v4, s[44:47], s52 offen offset:3072 lds
    v_mfma_f32_16x16x32_bf16 v[188:191], a[236:239], a[44:47], v[188:191]
    s_add_u32 m0, s53, 16384
    s_mov_b32 s52, 1146880
    buffer_load_dwordx4 v6, s[48:51], s52 offen offset:0 lds
    v_mfma_f32_16x16x32_bf16 v[204:207], a[236:239], a[144:147], v[204:207]
    s_mov_b32 s52, 1160192
    buffer_load_dwordx4 v6, s[48:51], s52 offen offset:1024 lds
    v_mfma_f32_16x16x32_bf16 v[204:207], a[236:239], a[148:151], v[204:207]
    s_mov_b32 s52, 1173504
    buffer_load_dwordx4 v6, s[48:51], s52 offen offset:2048 lds
    v_mfma_f32_16x16x32_bf16 v[204:207], a[236:239], a[152:155], v[204:207]
    s_mov_b32 s52, 1186816
    buffer_load_dwordx4 v6, s[48:51], s52 offen offset:3072 lds
    v_mfma_f32_16x16x32_bf16 v[204:207], a[236:239], a[156:159], v[204:207]
    s_waitcnt lgkmcnt(0)
    v_add_u32 v220, 0x0, v7
    v_add_u32 v221, 0x0, v8
    v_add_u32 v222, 0xfffefe00, v7
    v_add_u32 v223, 0xfffefe00, v8
    v_add_u32 v224, 0xffff8000, v7
    v_add_u32 v225, 0xffff8000, v8
    s_cmp_eq_u32 s3, 0
    s_cbranch_scc0 POLL_S2_D
    s_mov_b64 s[92:93], exec
    s_mov_b64 exec, 0xffff
    s_mov_b32 s94, 0
    s_waitcnt vmcnt(8)
    s_branch POLL_S2_C
POLL_S2_L:
    global_load_dword v245, v244, s[38:39] sc0 sc1
    s_waitcnt vmcnt(0)
POLL_S2_C:
    s_add_u32 s94, s94, 1
    v_cmp_gt_u32 vcc, 14, v245
    s_cmp_gt_u32 s94, 0x40000
    s_cbranch_scc1 POLL_S2_X
    s_and_b64 vcc, vcc, exec
    s_cbranch_vccz POLL_S2_X
    s_branch POLL_S2_L
POLL_S2_X:
    s_mov_b64 exec, s[92:93]
POLL_S2_D:
    s_barrier
    s_add_u32 m0, s53, 33280
    s_mov_b32 s52, 1376256
    buffer_load_dwordx4 v4, s[44:47], s52 offen offset:0 lds
    s_mov_b32 s52, 1389568
    buffer_load_dwordx4 v4, s[44:47], s52 offen offset:1024 lds
    s_mov_b32 s52, 1402880
    buffer_load_dwordx4 v4, s[44:47], s52 offen offset:2048 lds
    s_mov_b32 s52, 1416192
    buffer_load_dwordx4 v4, s[44:47], s52 offen offset:3072 lds
    s_add_u32 m0, s53, 49664
    s_mov_b32 s52, 1376256
    buffer_load_dwordx4 v6, s[48:51], s52 offen offset:0 lds
    s_mov_b32 s52, 1389568
    buffer_load_dwordx4 v6, s[48:51], s52 offen offset:1024 lds
    s_mov_b32 s52, 1402880
    buffer_load_dwordx4 v6, s[48:51], s52 offen offset:2048 lds
    s_mov_b32 s52, 1416192
    buffer_load_dwordx4 v6, s[48:51], s52 offen offset:3072 lds
    s_add_u32 m0, s55, 98816
    s_mov_b32 s89, 0
    buffer_load_dwordx4 v226, s[40:43], s89 offen sc1 lds
    v_bfe_u32 v17, v1, 2, 2
    v_lshrrev_b32 v16, 5, v1
    v_lshl_add_u32 v18, v16, 3, v17
    v_lshlrev_b32 v18, 7, v18
    v_bfe_u32 v19, v1, 4, 1
    v_lshl_add_u32 v18, v19, 5, v18
    v_and_b32 v19, 3, v1
    v_lshl_add_u32 v18, v19, 3, v18
    v_lshrrev_b32 v20, 1, v17
    v_lshl_add_u32 v18, v20, 6, v18
    s_mov_b32 s89, 32768
    buffer_load_dwordx4 v226, s[40:43], s89 offen offset:1024 sc1 lds
    v_add_u32 v2, 98816, v18
    v_xor_b32 v3, 64, v2
    v_add_u32 v12, 0, v18
    v_xor_b32 v13, 64, v12
    v_lshrrev_b32 v16, 4, v1
    v_lshl_add_u32 v16, v16, 3, v17
    v_lshlrev_b32 v16, 7, v16
    v_lshl_add_u32 v16, v19, 3, v16
    s_lshr_b32 s52, s3, 1
    v_xor_b32 v20, s52, v20
    s_add_u32 m0, s55, 107008
    s_mov_b32 s89, 270336
    buffer_load_dwordx4 v226, s[40:43], s89 offen sc1 lds
    v_lshl_add_u32 v16, v20, 6, v16
    s_and_b32 s52, s3, 1
    s_lshl_b32 s52, s52, 5
    v_add_u32 v16, s52, v16
    v_add_u32 v4, 98816, v16
    v_add_u32 v15, 0, v16
    v_and_b32 v16, 15, v1
    v_lshlrev_b32 v17, 3, v16
    s_lshl_b32 s52, s3, 7
    s_mov_b32 s89, 303104
    buffer_load_dwordx4 v226, s[40:43], s89 offen offset:1024 sc1 lds
    s_add_u32 s52, s52, 90112
    v_add_u32 v5, s52, v17
    v_lshlrev_b32 v6, 3, v1
    v_add_u32 v6, 90112, v6
    v_lshrrev_b32 v18, 4, v1
    v_lshrrev_b32 v16, 2, v16
    v_cmp_eq_u32 s[80:81], v16, v18
    s_mov_b32 s82, 0xaaaaaaaa
    s_mov_b32 s83, 0xaaaaaaaa
    s_add_u32 m0, s55, 115200
    s_mov_b32 s89, 540672
    buffer_load_dwordx4 v226, s[40:43], s89 offen sc1 lds
    s_mov_b32 s84, 0xcccccccc
    s_mov_b32 s85, 0xcccccccc
    s_mov_b32 s86, -1
    s_mov_b32 s87, 0
    v_lshrrev_b32 v16, 5, v1
    s_lshl_b32 s52, s3, 2
    v_add_u32 v16, s52, v16
    v_and_b32 v17, 15, v1
    v_and_b32 v18, 31, v1
    s_mov_b32 s89, 573440
    buffer_load_dwordx4 v226, s[40:43], s89 offen offset:1024 sc1 lds
    v_lshlrev_b32 v18, 8, v18
    v_add_u32 v18, 57344, v18
    v_xor_b32 v20, v16, v17
    v_lshl_add_u32 v7, v20, 4, v18
    v_xor_b32 v10, 32, v7
    v_lshrrev_b32 v16, 4, v1
    s_lshl_b32 s52, s3, 3
    v_add_u32 v16, s52, v16
    v_xor_b32 v18, v16, v17
    s_add_u32 m0, s55, 123392
    s_mov_b32 s89, 811008
    buffer_load_dwordx4 v226, s[40:43], s89 offen sc1 lds
    v_and_b32 v18, 15, v18
    v_lshlrev_b32 v18, 4, v18
    v_lshl_add_u32 v8, v16, 8, v18
    v_add_u32 v8, 57344, v8
    v_xor_b32 v11, 64, v8
    s_lshl_b32 s52, s4, 7
    v_add_u32 v16, s52, v16
    v_mul_u32_u24 v16, 3712, v16
    v_lshl_add_u32 v9, v17, 4, v16
    s_mov_b32 s89, 843776
    buffer_load_dwordx4 v226, s[40:43], s89 offen offset:1024 sc1 lds
    s_lshl_b32 s52, s5, 8
    s_add_u32 s52, s52, 0x400000
    v_add_u32 v9, s52, v9
    v_mov_b32 v153, 0
    v_mov_b32 v154, 0
    v_mov_b32 v155, 0
    v_mov_b32 v157, 0
    v_mov_b32 v158, 0
    v_mov_b32 v159, 0
    s_waitcnt lgkmcnt(0)
    v_mfma_f32_16x16x32_bf16 v[188:191], a[236:239], a[48:51], v[188:191]
    v_mfma_f32_16x16x32_bf16 v[188:191], a[236:239], a[52:55], v[188:191]
    v_mfma_f32_16x16x32_bf16 v[188:191], a[236:239], a[56:59], v[188:191]
    v_mfma_f32_16x16x32_bf16 v[188:191], a[236:239], a[60:63], v[188:191]
    v_mfma_f32_16x16x32_bf16 v[204:207], a[236:239], a[160:163], v[204:207]
    v_mfma_f32_16x16x32_bf16 v[204:207], a[236:239], a[164:167], v[204:207]
    v_mfma_f32_16x16x32_bf16 v[204:207], a[236:239], a[168:171], v[204:207]
    v_mfma_f32_16x16x32_bf16 v[204:207], a[236:239], a[172:175], v[204:207]
    s_cmp_ge_u32 s5, 7
    s_cselect_b32 s6, 1, 0
    s_mul_i32 s7, s6, 7
    s_sub_u32 s7, s5, s7
    s_lshl_b32 s52, s4, 1
    s_add_u32 s6, s6, s52
    s_mov_b32 s44, s32
    s_and_b32 s45, s33, 0xffff
    s_mov_b32 s46, 0x188000
    s_mov_b32 s47, 0x20000
    v_lshrrev_b32 v185, 3, v1
    v_and_b32 v186, 7, v1
    v_bfe_u32 v187, v1, 4, 1
    v_lshlrev_b32 v187, 2, v187
    v_xor_b32 v187, v187, v186
    v_mul_u32_u24 v186, 896, v185
    v_lshl_add_u32 v184, v187, 4, v186
    s_mul_i32 s52, s3, 448*896
    s_lshl_b32 s53, s7, 7
    s_add_u32 s52, s52, s53
    v_add_u32 v184, s52, v184
    s_mul_i32 s56, s3, 24576
    s_lshl_b32 s57, s3, 14
    s_add_u32 s57, s57, 98304
    s_and_b32 s52, s4, 3
    s_mul_i32 s52, s52, 448
    s_lshl_b32 s53, s3, 6
    v_add_u32 v246, s53, v1
    v_add_u32 v247, 256, v246
    v_cmp_gt_u32 vcc, 448, v247
    v_add_u32 v246, s52, v246
    v_add_u32 v247, s52, v247
    v_mul_u32_u24 v246, 896, v246
    v_mul_u32_u24 v247, 896, v247
    s_lshl_b32 s52, s7, 7
    v_add_u32 v246, s52, v246
    v_add_u32 v247, s52, v247
    v_mov_b32 v248, 0x40000000
    v_cndmask_b32 v247, v248, v247, vcc
    s_waitcnt vmcnt(6)
    s_barrier
    ds_read_b64_tr_b16 v[16:17], v2 offset:0
    ds_read_b64_tr_b16 v[18:19], v2 offset:512
    ds_read_b64_tr_b16 v[20:21], v2 offset:2048
    ds_read_b64_tr_b16 v[22:23], v2 offset:2560
    ds_read_b64_tr_b16 v[24:25], v2 offset:4096
    ds_read_b64_tr_b16 v[26:27], v2 offset:4608
    ds_read_b64_tr_b16 v[28:29], v2 offset:6144
    ds_read_b64_tr_b16 v[30:31], v2 offset:6656
    ds_read_b64_tr_b16 v[128:129], v4 offset:0
    ds_read_b64_tr_b16 v[130:131], v4 offset:512
    ds_read_b64_tr_b16 v[132:133], v4 offset:4096
    ds_read_b64_tr_b16 v[134:135], v4 offset:4608
    s_waitcnt vmcnt(4)
    s_barrier
    s_waitcnt lgkmcnt(0)
    v_mfma_f32_32x32x16_bf16 v[64:79], a[0:3], v[16:19], 0
    ds_read_b64_tr_b16 v[32:33], v2 offset:8192
    ds_read_b64_tr_b16 v[34:35], v2 offset:8704
    v_mfma_f32_32x32x16_bf16 v[80:95], a[112:115], v[16:19], 0
    ds_read_b64_tr_b16 v[36:37], v2 offset:10240
    ds_read_b64_tr_b16 v[38:39], v2 offset:10752
    s_add_u32 m0, s55, 131584
    s_mov_b32 s52, 1081344
    buffer_load_dwordx4 v226, s[40:43], s52 offen sc1 lds
    v_mfma_f32_16x16x32_bf16 v[148:151], v[128:131], v[128:131], 0
    ds_read_b64_tr_b16 v[40:41], v2 offset:12288
    ds_read_b64_tr_b16 v[42:43], v2 offset:12800
    v_mfma_f32_32x32x16_bf16 v[64:79], a[4:7], v[20:23], v[64:79]
    ds_read_b64_tr_b16 v[44:45], v2 offset:14336
    ds_read_b64_tr_b16 v[46:47], v2 offset:14848
    ds_read_b64_tr_b16 a[64:65], v220 offset:0
    ds_read_b64_tr_b16 a[66:67], v220 offset:1024
    v_mfma_f32_32x32x16_bf16 v[80:95], a[116:119], v[20:23], v[80:95]
    ds_read_b64_tr_b16 v[136:137], v4 offset:8192
    ds_read_b64_tr_b16 v[138:139], v4 offset:8704
    ds_read_b64_tr_b16 a[68:69], v220 offset:4096
    ds_read_b64_tr_b16 a[70:71], v220 offset:5120
    v_mfma_f32_16x16x32_bf16 v[144:147], a[232:235], v[128:131], 0
    ds_read_b64_tr_b16 v[140:141], v4 offset:12288
    ds_read_b64_tr_b16 v[142:143], v4 offset:12800
    v_mfma_f32_32x32x16_bf16 v[64:79], a[8:11], v[24:27], v[64:79]
    ds_read_b64_tr_b16 a[72:73], v220 offset:8192
    ds_read_b64_tr_b16 a[74:75], v220 offset:9216
    ds_read_b64_tr_b16 a[76:77], v220 offset:12288
    v_mfma_f32_32x32x16_bf16 v[80:95], a[120:123], v[24:27], v[80:95]
    ds_read_b64_tr_b16 a[78:79], v220 offset:13312
    s_mov_b32 s52, 1114112
    buffer_load_dwordx4 v226, s[40:43], s52 offen offset:1024 sc1 lds
    v_mfma_f32_16x16x32_bf16 v[148:151], v[132:135], v[132:135], v[148:151]
    ds_read_b64_tr_b16 a[176:177], v221 offset:0
    v_mfma_f32_32x32x16_bf16 v[64:79], a[12:15], v[28:31], v[64:79]
    ds_read_b64_tr_b16 a[178:179], v221 offset:1024
    ds_read_b64_tr_b16 a[180:181], v221 offset:4096
    ds_read_b64_tr_b16 a[182:183], v221 offset:5120
    v_mfma_f32_32x32x16_bf16 v[80:95], a[124:127], v[28:31], v[80:95]
    ds_read_b64_tr_b16 a[184:185], v221 offset:8192
    ds_read_b64_tr_b16 a[186:187], v221 offset:9216
    ds_read_b64_tr_b16 a[188:189], v221 offset:12288
    v_mfma_f32_16x16x32_bf16 v[144:147], a[232:235], v[132:135], v[144:147]
    ds_read_b64_tr_b16 a[190:191], v221 offset:13312
    s_waitcnt vmcnt(4)
    s_barrier
    s_waitcnt lgkmcnt(12)
    v_mfma_f32_32x32x16_bf16 v[64:79], a[16:19], v[32:35], v[64:79]
    ds_read_b64_tr_b16 v[16:17], v2 offset:16384
    v_mfma_f32_32x32x16_bf16 v[80:95], a[128:131], v[32:35], v[80:95]
    ds_read_b64_tr_b16 v[18:19], v2 offset:16896
    s_add_u32 m0, s55, 139776
    s_mov_b32 s52, 1351680
    buffer_load_dwordx4 v226, s[40:43], s52 offen sc1 lds
    v_mfma_f32_16x16x32_bf16 v[148:151], v[136:139], v[136:139], v[148:151]
    ds_read_b64_tr_b16 v[20:21], v2 offset:18432
    v_mfma_f32_16x16x32_bf16 v[188:191], a[236:239], a[64:67], v[188:191]
    ds_read_b64_tr_b16 v[22:23], v2 offset:18944
    ds_read_b64_tr_b16 a[80:81], v222 offset:0
    v_mfma_f32_16x16x32_bf16 v[188:191], a[236:239], a[68:71], v[188:191]
    ds_read_b64_tr_b16 v[24:25], v2 offset:20480
    v_mfma_f32_32x32x16_bf16 v[64:79], a[20:23], v[36:39], v[64:79]
    ds_read_b64_tr_b16 v[26:27], v2 offset:20992
    ds_read_b64_tr_b16 a[82:83], v222 offset:1024
    ds_read_b64_tr_b16 a[84:85], v222 offset:4096
    v_mfma_f32_32x32x16_bf16 v[80:95], a[132:135], v[36:39], v[80:95]
    ds_read_b64_tr_b16 v[28:29], v2 offset:22528
    ds_read_b64_tr_b16 a[86:87], v222 offset:5120
    ds_read_b64_tr_b16 a[88:89], v222 offset:8192
    v_mfma_f32_16x16x32_bf16 v[144:147], a[232:235], v[136:139], v[144:147]
    ds_read_b64_tr_b16 v[30:31], v2 offset:23040
    v_mfma_f32_16x16x32_bf16 v[188:191], a[236:239], a[72:75], v[188:191]
    ds_read_b64_tr_b16 v[128:129], v4 offset:16384
    v_mfma_f32_16x16x32_bf16 v[188:191], a[236:239], a[76:79], v[188:191]
    ds_read_b64_tr_b16 v[130:131], v4 offset:16896
    ds_read_b64_tr_b16 a[90:91], v222 offset:9216
    v_mfma_f32_32x32x16_bf16 v[64:79], a[24:27], v[40:43], v[64:79]
    ds_read_b64_tr_b16 v[132:133], v4 offset:20480
    ds_read_b64_tr_b16 a[92:93], v222 offset:12288
    ds_read_b64_tr_b16 a[94:95], v222 offset:13312
    v_mfma_f32_32x32x16_bf16 v[80:95], a[136:139], v[40:43], v[80:95]
    ds_read_b64_tr_b16 v[134:135], v4 offset:20992
    v_mfma_f32_16x16x32_bf16 v[148:151], v[140:143], v[140:143], v[148:151]
    s_mov_b32 s52, 1384448
    buffer_load_dwordx4 v226, s[40:43], s52 offen offset:1024 sc1 lds
    v_mfma_f32_16x16x32_bf16 v[204:207], a[236:239], a[176:179], v[204:207]
    v_mfma_f32_16x16x32_bf16 v[204:207], a[236:239], a[180:183], v[204:207]
    ds_read_b64_tr_b16 a[192:193], v223 offset:0
    v_mfma_f32_32x32x16_bf16 v[64:79], a[28:31], v[44:47], v[64:79]
    ds_read_b64_tr_b16 a[194:195], v223 offset:1024
    ds_read_b64_tr_b16 a[196:197], v223 offset:4096
    v_mfma_f32_32x32x16_bf16 v[80:95], a[140:143], v[44:47], v[80:95]
    ds_read_b64_tr_b16 a[198:199], v223 offset:5120
    ds_read_b64_tr_b16 a[200:201], v223 offset:8192
    ds_read_b64_tr_b16 a[202:203], v223 offset:9216
    v_mfma_f32_16x16x32_bf16 v[144:147], a[232:235], v[140:143], v[144:147]
    v_mfma_f32_16x16x32_bf16 v[204:207], a[236:239], a[184:187], v[204:207]
    ds_read_b64_tr_b16 a[204:205], v223 offset:12288
    v_mfma_f32_16x16x32_bf16 v[204:207], a[236:239], a[188:191], v[204:207]
    ds_read_b64_tr_b16 a[206:207], v223 offset:13312
    s_waitcnt vmcnt(4)
    s_barrier
    s_waitcnt lgkmcnt(8)
    v_mfma_f32_32x32x16_bf16 v[64:79], a[32:35], v[16:19], v[64:79]
    ds_read_b64_tr_b16 v[32:33], v2 offset:24576
    v_mfma_f32_32x32x16_bf16 v[80:95], a[144:147], v[16:19], v[80:95]
    ds_read_b64_tr_b16 v[34:35], v2 offset:25088
    s_add_u32 m0, s55, 147968
    s_mov_b32 s52, 1622016
    buffer_load_dwordx4 v226, s[40:43], s52 offen sc1 lds
    v_mfma_f32_16x16x32_bf16 v[148:151], v[128:131], v[128:131], v[148:151]
    ds_read_b64_tr_b16 v[36:37], v2 offset:26624
    v_mfma_f32_16x16x32_bf16 v[188:191], a[236:239], a[80:83], v[188:191]
    ds_read_b64_tr_b16 v[38:39], v2 offset:27136
    ds_read_b64_tr_b16 a[96:97], v224 offset:0
    v_mfma_f32_16x16x32_bf16 v[188:191], a[236:239], a[84:87], v[188:191]
    ds_read_b64_tr_b16 v[40:41], v2 offset:28672
    v_mfma_f32_32x32x16_bf16 v[64:79], a[36:39], v[20:23], v[64:79]
    ds_read_b64_tr_b16 v[42:43], v2 offset:29184
    ds_read_b64_tr_b16 a[98:99], v224 offset:1024
    ds_read_b64_tr_b16 a[100:101], v224 offset:4096
    v_mfma_f32_32x32x16_bf16 v[80:95], a[148:151], v[20:23], v[80:95]
    ds_read_b64_tr_b16 v[44:45], v2 offset:30720
    ds_read_b64_tr_b16 a[102:103], v224 offset:5120
    ds_read_b64_tr_b16 a[104:105], v224 offset:8192
    v_mfma_f32_16x16x32_bf16 v[144:147], a[232:235], v[128:131], v[144:147]
    ds_read_b64_tr_b16 v[46:47], v2 offset:31232
    v_mfma_f32_16x16x32_bf16 v[188:191], a[236:239], a[88:91], v[188:191]
    ds_read_b64_tr_b16 v[136:137], v4 offset:24576
    v_mfma_f32_16x16x32_bf16 v[188:191], a[236:239], a[92:95], v[188:191]
    ds_read_b64_tr_b16 v[138:139], v4 offset:25088
    ds_read_b64_tr_b16 a[106:107], v224 offset:9216
    v_mfma_f32_32x32x16_bf16 v[64:79], a[40:43], v[24:27], v[64:79]
    ds_read_b64_tr_b16 v[140:141], v4 offset:28672
    ds_read_b64_tr_b16 a[108:109], v224 offset:12288
    ds_read_b64_tr_b16 a[110:111], v224 offset:13312
    v_mfma_f32_32x32x16_bf16 v[80:95], a[152:155], v[24:27], v[80:95]
    ds_read_b64_tr_b16 v[142:143], v4 offset:29184
    v_mfma_f32_16x16x32_bf16 v[148:151], v[132:135], v[132:135], v[148:151]
    s_mov_b32 s52, 1654784
    buffer_load_dwordx4 v226, s[40:43], s52 offen offset:1024 sc1 lds
    v_mfma_f32_16x16x32_bf16 v[204:207], a[236:239], a[192:195], v[204:207]
    v_mfma_f32_16x16x32_bf16 v[204:207], a[236:239], a[196:199], v[204:207]
    ds_read_b64_tr_b16 a[208:209], v225 offset:0
    v_mfma_f32_32x32x16_bf16 v[64:79], a[44:47], v[28:31], v[64:79]
    ds_read_b64_tr_b16 a[210:211], v225 offset:1024
    ds_read_b64_tr_b16 a[212:213], v225 offset:4096
    v_mfma_f32_32x32x16_bf16 v[80:95], a[156:159], v[28:31], v[80:95]
    ds_read_b64_tr_b16 a[214:215], v225 offset:5120
    ds_read_b64_tr_b16 a[216:217], v225 offset:8192
    ds_read_b64_tr_b16 a[218:219], v225 offset:9216
    v_mfma_f32_16x16x32_bf16 v[144:147], a[232:235], v[132:135], v[144:147]
    v_mfma_f32_16x16x32_bf16 v[204:207], a[236:239], a[200:203], v[204:207]
    ds_read_b64_tr_b16 a[220:221], v225 offset:12288
    v_mfma_f32_16x16x32_bf16 v[204:207], a[236:239], a[204:207], v[204:207]
    ds_read_b64_tr_b16 a[222:223], v225 offset:13312
    s_waitcnt vmcnt(4)
    s_barrier
    s_waitcnt lgkmcnt(8)
    v_mfma_f32_32x32x16_bf16 v[64:79], a[48:51], v[32:35], v[64:79]
    ds_read_b64_tr_b16 v[16:17], v2 offset:32768
    v_mfma_f32_32x32x16_bf16 v[80:95], a[160:163], v[32:35], v[80:95]
    ds_read_b64_tr_b16 v[18:19], v2 offset:33280
    v_mfma_f32_16x16x32_bf16 v[148:151], v[136:139], v[136:139], v[148:151]
    ds_read_b64_tr_b16 v[20:21], v2 offset:34816
    v_mfma_f32_16x16x32_bf16 v[188:191], a[236:239], a[96:99], v[188:191]
    ds_read_b64_tr_b16 v[22:23], v2 offset:35328
    v_mfma_f32_16x16x32_bf16 v[188:191], a[236:239], a[100:103], v[188:191]
    ds_read_b64_tr_b16 v[24:25], v2 offset:36864
    v_mfma_f32_32x32x16_bf16 v[64:79], a[52:55], v[36:39], v[64:79]
    ds_read_b64_tr_b16 v[26:27], v2 offset:37376
    v_mfma_f32_32x32x16_bf16 v[80:95], a[164:167], v[36:39], v[80:95]
    ds_read_b64_tr_b16 v[28:29], v2 offset:38912
    v_mfma_f32_16x16x32_bf16 v[144:147], a[232:235], v[136:139], v[144:147]
    ds_read_b64_tr_b16 v[30:31], v2 offset:39424
    v_mfma_f32_16x16x32_bf16 v[188:191], a[236:239], a[104:107], v[188:191]
    ds_read_b64_tr_b16 v[128:129], v4 offset:32768
    v_mfma_f32_16x16x32_bf16 v[188:191], a[236:239], a[108:111], v[188:191]
    ds_read_b64_tr_b16 v[130:131], v4 offset:33280
    v_mfma_f32_32x32x16_bf16 v[64:79], a[56:59], v[40:43], v[64:79]
    ds_read_b64_tr_b16 v[132:133], v4 offset:36864
    v_mfma_f32_32x32x16_bf16 v[80:95], a[168:171], v[40:43], v[80:95]
    ds_read_b64_tr_b16 v[134:135], v4 offset:37376
    s_add_u32 m0, s55, 0
    s_mov_b32 s52, 128
    buffer_load_dwordx4 v226, s[40:43], s52 offen sc1 lds
    v_mfma_f32_16x16x32_bf16 v[148:151], v[140:143], v[140:143], v[148:151]
    v_mfma_f32_16x16x32_bf16 v[204:207], a[236:239], a[208:211], v[204:207]
    v_mfma_f32_16x16x32_bf16 v[204:207], a[236:239], a[212:215], v[204:207]
    v_mfma_f32_32x32x16_bf16 v[64:79], a[60:63], v[44:47], v[64:79]
    v_mfma_f32_32x32x16_bf16 v[80:95], a[172:175], v[44:47], v[80:95]
    v_mfma_f32_16x16x32_bf16 v[144:147], a[232:235], v[140:143], v[144:147]
    s_waitcnt lgkmcnt(14)
    v_mfma_f32_16x16x32_bf16 v[204:207], a[236:239], a[216:219], v[204:207]
    s_mov_b32 s52, 32896
    buffer_load_dwordx4 v226, s[40:43], s52 offen offset:1024 sc1 lds
    s_waitcnt lgkmcnt(12)
    v_mfma_f32_16x16x32_bf16 v[204:207], a[236:239], a[220:223], v[204:207]
    s_waitcnt vmcnt(4)
    s_barrier
    s_waitcnt lgkmcnt(0)
    v_mfma_f32_32x32x16_bf16 v[64:79], a[64:67], v[16:19], v[64:79]
    ds_read_b64_tr_b16 v[32:33], v2 offset:40960
    ds_read_b64_tr_b16 v[34:35], v2 offset:41472
    v_mfma_f32_32x32x16_bf16 v[80:95], a[176:179], v[16:19], v[80:95]
    ds_read_b64_tr_b16 v[36:37], v2 offset:43008
    ds_read_b64_tr_b16 v[38:39], v2 offset:43520
    v_mfma_f32_16x16x32_bf16 v[148:151], v[128:131], v[128:131], v[148:151]
    ds_read_b64_tr_b16 v[40:41], v2 offset:45056
    ds_read_b64_tr_b16 v[42:43], v2 offset:45568
    v_mfma_f32_32x32x16_bf16 v[64:79], a[68:71], v[20:23], v[64:79]
    ds_read_b64_tr_b16 v[44:45], v2 offset:47104
    ds_read_b64_tr_b16 v[46:47], v2 offset:47616
    v_mfma_f32_32x32x16_bf16 v[80:95], a[180:183], v[20:23], v[80:95]
    ds_read_b64_tr_b16 v[136:137], v4 offset:40960
    ds_read_b64_tr_b16 v[138:139], v4 offset:41472
    v_mfma_f32_16x16x32_bf16 v[144:147], a[232:235], v[128:131], v[144:147]
    ds_read_b64_tr_b16 v[140:141], v4 offset:45056
    ds_read_b64_tr_b16 v[142:143], v4 offset:45568
    v_mfma_f32_32x32x16_bf16 v[64:79], a[72:75], v[24:27], v[64:79]
    v_mfma_f32_32x32x16_bf16 v[80:95], a[184:187], v[24:27], v[80:95]
    s_add_u32 m0, s55, 8192
    s_mov_b32 s52, 270464
    buffer_load_dwordx4 v226, s[40:43], s52 offen sc1 lds
    v_mfma_f32_16x16x32_bf16 v[148:151], v[132:135], v[132:135], v[148:151]
    v_mfma_f32_32x32x16_bf16 v[64:79], a[76:79], v[28:31], v[64:79]
    v_mfma_f32_32x32x16_bf16 v[80:95], a[188:191], v[28:31], v[80:95]
    v_mfma_f32_16x16x32_bf16 v[144:147], a[232:235], v[132:135], v[144:147]
    s_mov_b32 s52, 303232
    buffer_load_dwordx4 v226, s[40:43], s52 offen offset:1024 sc1 lds
    s_waitcnt vmcnt(4)
    s_barrier
    s_waitcnt lgkmcnt(0)
    v_mfma_f32_32x32x16_bf16 v[64:79], a[80:83], v[32:35], v[64:79]
    ds_read_b64_tr_b16 v[16:17], v2 offset:49152
    ds_read_b64_tr_b16 v[18:19], v2 offset:49664
    v_mfma_f32_32x32x16_bf16 v[80:95], a[192:195], v[32:35], v[80:95]
    ds_read_b64_tr_b16 v[20:21], v2 offset:51200
    ds_read_b64_tr_b16 v[22:23], v2 offset:51712
    s_add_u32 m0, s55, 16384
    s_mov_b32 s52, 540800
    buffer_load_dwordx4 v226, s[40:43], s52 offen sc1 lds
    v_permlane16_swap_b32 v188, v189
    v_mfma_f32_16x16x32_bf16 v[148:151], v[136:139], v[136:139], v[148:151]
    ds_read_b64_tr_b16 v[24:25], v2 offset:53248
    ds_read_b64_tr_b16 v[26:27], v2 offset:53760
    v_mfma_f32_32x32x16_bf16 v[64:79], a[84:87], v[36:39], v[64:79]
    ds_read_b64_tr_b16 v[28:29], v2 offset:55296
    ds_read_b64_tr_b16 v[30:31], v2 offset:55808
    v_cvt_pk_bf16_f32 v189, v188, v188
    v_lshlrev_b32 v189, 16, v189
    v_mfma_f32_32x32x16_bf16 v[80:95], a[196:199], v[36:39], v[80:95]
    ds_read_b64_tr_b16 v[128:129], v4 offset:49152
    ds_read_b64_tr_b16 v[130:131], v4 offset:49664
    v_sub_f32 v188, v188, v189
    v_cvt_pk_bf16_f32 v188, v189, v188
    v_cndmask_b32 v188, 0, v188, s[86:87]
    v_mfma_f32_16x16x32_bf16 v[144:147], a[232:235], v[136:139], v[144:147]
    ds_read_b64_tr_b16 v[132:133], v4 offset:53248
    ds_read_b64_tr_b16 v[134:135], v4 offset:53760
    v_mfma_f32_32x32x16_bf16 v[64:79], a[88:91], v[40:43], v[64:79]
    v_accvgpr_write_b32 a224, v188
    v_accvgpr_write_b32 a225, 0
    v_accvgpr_write_b32 a226, 0
    v_mfma_f32_32x32x16_bf16 v[80:95], a[200:203], v[40:43], v[80:95]
    v_accvgpr_write_b32 a227, 0
    s_mov_b32 s52, 573568
    buffer_load_dwordx4 v226, s[40:43], s52 offen offset:1024 sc1 lds
    v_mfma_f32_16x16x32_bf16 v[148:151], v[140:143], v[140:143], v[148:151]
    v_permlane16_swap_b32 v204, v205
    v_mfma_f32_32x32x16_bf16 v[64:79], a[92:95], v[44:47], v[64:79]
    v_cvt_pk_bf16_f32 v205, v204, v204
    v_lshlrev_b32 v205, 16, v205
    v_sub_f32 v204, v204, v205
    v_cvt_pk_bf16_f32 v204, v205, v204
    v_mfma_f32_32x32x16_bf16 v[80:95], a[204:207], v[44:47], v[80:95]
    v_cndmask_b32 v204, 0, v204, s[86:87]
    v_accvgpr_write_b32 a228, v204
    v_accvgpr_write_b32 a229, 0
    v_accvgpr_write_b32 a230, 0
    v_mfma_f32_16x16x32_bf16 v[144:147], a[232:235], v[140:143], v[144:147]
    v_accvgpr_write_b32 a231, 0
    s_waitcnt lgkmcnt(0)
    v_mfma_f32_32x32x16_bf16 v[64:79], a[96:99], v[16:19], v[64:79]
    ds_read_b64_tr_b16 v[32:33], v3 offset:0
    v_mfma_f32_32x32x16_bf16 v[80:95], a[208:211], v[16:19], v[80:95]
    ds_read_b64_tr_b16 v[34:35], v3 offset:512
    v_mfma_f32_16x16x32_bf16 v[148:151], v[128:131], v[128:131], v[148:151]
    ds_read_b64_tr_b16 v[36:37], v3 offset:2048
    v_mfma_f32_32x32x16_bf16 v[64:79], a[100:103], v[20:23], v[64:79]
    ds_read_b64_tr_b16 v[38:39], v3 offset:2560
    v_mfma_f32_32x32x16_bf16 v[80:95], a[212:215], v[20:23], v[80:95]
    ds_read_b64_tr_b16 v[40:41], v3 offset:4096
    v_mfma_f32_16x16x32_bf16 v[144:147], a[232:235], v[128:131], v[144:147]
    ds_read_b64_tr_b16 v[42:43], v3 offset:4608
    v_mfma_f32_32x32x16_bf16 v[64:79], a[104:107], v[24:27], v[64:79]
    ds_read_b64_tr_b16 v[44:45], v3 offset:6144
    s_add_u32 m0, s55, 24576
    s_mov_b32 s52, 811136
    buffer_load_dwordx4 v226, s[40:43], s52 offen sc1 lds
    v_mfma_f32_32x32x16_bf16 v[80:95], a[216:219], v[24:27], v[80:95]
    ds_read_b64_tr_b16 v[46:47], v3 offset:6656
    v_mfma_f32_16x16x32_bf16 v[148:151], v[132:135], v[132:135], v[148:151]
    v_mfma_f32_32x32x16_bf16 v[64:79], a[108:111], v[28:31], v[64:79]
    v_mfma_f32_32x32x16_bf16 v[80:95], a[220:223], v[28:31], v[80:95]
    v_mfma_f32_16x16x32_bf16 v[144:147], a[232:235], v[132:135], v[144:147]
    s_mov_b32 s52, 843904
    buffer_load_dwordx4 v226, s[40:43], s52 offen offset:1024 sc1 lds
    s_nop 2
    v_cndmask_b32 v148, v148, v149, s[82:83]
    v_cndmask_b32 v150, v150, v151, s[82:83]
    s_nop 0
    v_cndmask_b32 v145, v148, v150, s[84:85]
    s_mov_b64 s[88:89], exec
    s_mov_b64 exec, s[80:81]
    ds_write_b64 v5, v[144:145] offset:0
    s_mov_b64 exec, s[88:89]
    s_waitcnt lgkmcnt(1)
    v_mfma_f32_32x32x16_bf16 v[96:111], a[0:3], v[32:35], 0
    ds_read_b64_tr_b16 v[16:17], v3 offset:8192
    ds_read_b64_tr_b16 v[18:19], v3 offset:8704
    v_mfma_f32_32x32x16_bf16 v[112:127], a[112:115], v[32:35], 0
    ds_read_b64_tr_b16 v[20:21], v3 offset:10240
    ds_read_b64_tr_b16 v[22:23], v3 offset:10752
    v_mfma_f32_32x32x16_bf16 v[96:111], a[4:7], v[36:39], v[96:111]
    ds_read_b64_tr_b16 v[24:25], v3 offset:12288
    ds_read_b64_tr_b16 v[26:27], v3 offset:12800
    v_mfma_f32_32x32x16_bf16 v[112:127], a[116:119], v[36:39], v[112:127]
    ds_read_b64_tr_b16 v[28:29], v3 offset:14336
    ds_read_b64_tr_b16 v[30:31], v3 offset:14848
    v_mfma_f32_32x32x16_bf16 v[96:111], a[8:11], v[40:43], v[96:111]
    s_add_u32 m0, s55, 32768
    s_mov_b32 s52, 1081472
    buffer_load_dwordx4 v226, s[40:43], s52 offen sc1 lds
    v_mfma_f32_32x32x16_bf16 v[112:127], a[120:123], v[40:43], v[112:127]
    v_mfma_f32_32x32x16_bf16 v[96:111], a[12:15], v[44:47], v[96:111]
    v_mfma_f32_32x32x16_bf16 v[112:127], a[124:127], v[44:47], v[112:127]
    s_mov_b32 s52, 1114240
    buffer_load_dwordx4 v226, s[40:43], s52 offen offset:1024 sc1 lds
    s_waitcnt lgkmcnt(8)
    s_barrier
    s_waitcnt lgkmcnt(0)
    v_mfma_f32_32x32x16_bf16 v[96:111], a[16:19], v[16:19], v[96:111]
    ds_read_b64_tr_b16 v[32:33], v3 offset:16384
    ds_read_b64_tr_b16 v[34:35], v3 offset:16896
    s_add_u32 m0, s55, 40960
    s_mov_b32 s52, 1351808
    buffer_load_dwordx4 v226, s[40:43], s52 offen sc1 lds
    v_mfma_f32_32x32x16_bf16 v[112:127], a[128:131], v[16:19], v[112:127]
    ds_read_b64_tr_b16 v[36:37], v3 offset:18432
    ds_read_b64_tr_b16 v[38:39], v3 offset:18944
    ds_read_b64 v[168:169], v6 offset:0
    s_waitcnt lgkmcnt(0)
    v_mul_f32 v168, 0x3b124925, v168
    v_mul_f32 v169, 0x3b124925, v169
    v_mfma_f32_32x32x16_bf16 v[96:111], a[20:23], v[20:23], v[96:111]
    ds_read_b64_tr_b16 v[40:41], v3 offset:20480
    ds_read_b64_tr_b16 v[42:43], v3 offset:20992
    v_fma_f32 v169, -v168, v168, v169
    v_max_f32 v169, 0, v169
    v_cvt_pk_bf16_f32 v172, -v168, v169
    v_and_b32 v169, 0xffff0000, v172
    v_mfma_f32_32x32x16_bf16 v[112:127], a[132:135], v[20:23], v[112:127]
    ds_read_b64_tr_b16 v[44:45], v3 offset:22528
    ds_read_b64_tr_b16 v[46:47], v3 offset:23040
    v_add_f32 v169, 0x3727c5ac, v169
    v_cvt_pk_bf16_f32 v169, v169, v169
    v_lshlrev_b32 v169, 16, v169
    v_mfma_f32_32x32x16_bf16 v[96:111], a[24:27], v[24:27], v[96:111]
    v_sqrt_f32 v169, v169
    v_and_b32 v172, 0xffff, v172
    v_cvt_pk_bf16_f32 v169, v169, v169
    v_lshlrev_b32 v169, 16, v169
    v_mfma_f32_32x32x16_bf16 v[112:127], a[136:139], v[24:27], v[112:127]
    s_mov_b32 s52, 1384576
    buffer_load_dwordx4 v226, s[40:43], s52 offen offset:1024 sc1 lds
    v_lshl_or_b32 v172, v172, 16, v172
    v_rcp_f32 v173, v169
    v_mul_f32 v174, v169, v169
    v_mfma_f32_32x32x16_bf16 v[96:111], a[28:31], v[28:31], v[96:111]
    v_mul_f32 v173, 0xbfb8aa3b, v173
    v_mov_b32 v152, v172
    v_mov_b32 v156, v172
    s_nop 1
    v_permlane32_swap_b32 v152, v156
    v_mov_b32 v48, v173
    v_mfma_f32_32x32x16_bf16 v[112:127], a[140:143], v[28:31], v[112:127]
    v_mov_b32 v52, v173
    s_nop 1
    v_permlane32_swap_b32 v48, v52
    v_mov_b32 v50, v174
    v_mov_b32 v54, v174
    s_nop 1
    v_permlane32_swap_b32 v50, v54
    v_cndmask_b32 v152, 0, v152, s[86:87]
    s_waitcnt lgkmcnt(0)
    v_mfma_f32_32x32x16_bf16 v[96:111], a[32:35], v[32:35], v[96:111]
    ds_read_b64_tr_b16 v[16:17], v3 offset:24576
    ds_read_b64_tr_b16 v[18:19], v3 offset:25088
    v_cndmask_b32 v156, 0, v156, s[86:87]
    v_mfma_f32_32x32x16_bf16 v[64:79], a[224:227], v[152:155], v[64:79]
    ds_read_b64_tr_b16 v[20:21], v3 offset:26624
    ds_read_b64_tr_b16 v[22:23], v3 offset:27136
    v_mfma_f32_32x32x16_bf16 v[80:95], a[228:231], v[152:155], v[80:95]
    ds_read_b64_tr_b16 v[24:25], v3 offset:28672
    ds_read_b64_tr_b16 v[26:27], v3 offset:29184
    v_mfma_f32_32x32x16_bf16 v[112:127], a[144:147], v[32:35], v[112:127]
    ds_read_b64_tr_b16 v[28:29], v3 offset:30720
    ds_read_b64_tr_b16 v[30:31], v3 offset:31232
    v_mfma_f32_32x32x16_bf16 v[96:111], a[36:39], v[36:39], v[96:111]
    s_add_u32 m0, s55, 49152
    s_mov_b32 s52, 1622144
    buffer_load_dwordx4 v226, s[40:43], s52 offen sc1 lds
    v_mfma_f32_32x32x16_bf16 v[112:127], a[148:151], v[36:39], v[112:127]
    s_mov_b32 s52, 1654912
    buffer_load_dwordx4 v226, s[40:43], s52 offen offset:1024 sc1 lds
    v_mfma_f32_32x32x16_bf16 v[96:111], a[40:43], v[40:43], v[96:111]
    v_mul_f32 v56, v64, v48
    v_mul_f32 v57, v65, v48
    v_mul_f32 v58, v66, v48
    v_mul_f32 v59, v67, v48
    v_mfma_f32_32x32x16_bf16 v[112:127], a[152:155], v[40:43], v[112:127]
    v_mul_f32 v60, v68, v48
    v_mul_f32 v61, v69, v48
    v_mul_f32 v62, v70, v48
    v_mul_f32 v63, v71, v48
    v_mfma_f32_32x32x16_bf16 v[96:111], a[44:47], v[44:47], v[96:111]
    v_exp_f32 v56, v56
    v_exp_f32 v57, v57
    v_mfma_f32_32x32x16_bf16 v[112:127], a[156:159], v[44:47], v[112:127]
    v_exp_f32 v58, v58
    v_exp_f32 v59, v59
    v_exp_f32 v60, v60
    s_waitcnt lgkmcnt(0)
    v_mfma_f32_32x32x16_bf16 v[96:111], a[48:51], v[16:19], v[96:111]
    ds_read_b64_tr_b16 v[32:33], v3 offset:32768
    ds_read_b64_tr_b16 v[34:35], v3 offset:33280
    v_exp_f32 v61, v61
    v_mfma_f32_32x32x16_bf16 v[112:127], a[160:163], v[16:19], v[112:127]
    ds_read_b64_tr_b16 v[36:37], v3 offset:34816
    ds_read_b64_tr_b16 v[38:39], v3 offset:35328
    v_exp_f32 v62, v62
    v_exp_f32 v63, v63
    v_mfma_f32_32x32x16_bf16 v[96:111], a[52:55], v[20:23], v[96:111]
    ds_read_b64_tr_b16 v[40:41], v3 offset:36864
    ds_read_b64_tr_b16 v[42:43], v3 offset:37376
    v_mul_f32 v64, v64, v72
    v_mul_f32 v65, v65, v73
    v_mul_f32 v66, v66, v74
    v_mfma_f32_32x32x16_bf16 v[112:127], a[164:167], v[20:23], v[112:127]
    ds_read_b64_tr_b16 v[44:45], v3 offset:38912
    ds_read_b64_tr_b16 v[46:47], v3 offset:39424
    v_mul_f32 v67, v67, v75
    v_mul_f32 v68, v68, v76
    v_mul_f32 v69, v69, v77
    v_mfma_f32_32x32x16_bf16 v[96:111], a[56:59], v[24:27], v[96:111]
    v_mul_f32 v70, v70, v78
    v_mul_f32 v71, v71, v79
    v_fma_f32 v56, v56, v50, v50
    v_fma_f32 v57, v57, v50, v50
    v_mfma_f32_32x32x16_bf16 v[112:127], a[168:171], v[24:27], v[112:127]
    v_fma_f32 v58, v58, v50, v50
    v_fma_f32 v59, v59, v50, v50
    v_fma_f32 v60, v60, v50, v50
    v_fma_f32 v61, v61, v50, v50
    v_mfma_f32_32x32x16_bf16 v[96:111], a[60:63], v[28:31], v[96:111]
    v_fma_f32 v62, v62, v50, v50
    v_fma_f32 v63, v63, v50, v50
    v_rcp_f32 v56, v56
    v_mfma_f32_32x32x16_bf16 v[112:127], a[172:175], v[28:31], v[112:127]
    v_rcp_f32 v57, v57
    v_rcp_f32 v58, v58
    v_rcp_f32 v59, v59
    s_waitcnt lgkmcnt(0)
    v_mfma_f32_32x32x16_bf16 v[96:111], a[64:67], v[32:35], v[96:111]
    ds_read_b64_tr_b16 v[16:17], v3 offset:40960
    ds_read_b64_tr_b16 v[18:19], v3 offset:41472
    v_rcp_f32 v60, v60
    v_mfma_f32_32x32x16_bf16 v[112:127], a[176:179], v[32:35], v[112:127]
    ds_read_b64_tr_b16 v[20:21], v3 offset:43008
    ds_read_b64_tr_b16 v[22:23], v3 offset:43520
    v_rcp_f32 v61, v61
    v_rcp_f32 v62, v62
    v_mfma_f32_32x32x16_bf16 v[96:111], a[68:71], v[36:39], v[96:111]
    ds_read_b64_tr_b16 v[24:25], v3 offset:45056
    ds_read_b64_tr_b16 v[26:27], v3 offset:45568
    v_rcp_f32 v63, v63
    v_mul_f32 v64, v64, v56
    v_mul_f32 v65, v65, v57
    v_mfma_f32_32x32x16_bf16 v[112:127], a[180:183], v[36:39], v[112:127]
    ds_read_b64_tr_b16 v[28:29], v3 offset:47104
    ds_read_b64_tr_b16 v[30:31], v3 offset:47616
    v_mul_f32 v66, v66, v58
    v_mul_f32 v67, v67, v59
    v_mul_f32 v68, v68, v60
    v_mfma_f32_32x32x16_bf16 v[96:111], a[72:75], v[40:43], v[96:111]
    v_mul_f32 v69, v69, v61
    v_mul_f32 v70, v70, v62
    v_mul_f32 v71, v71, v63
    v_cvt_pk_bf16_f32 v160, v64, v65
    v_mfma_f32_32x32x16_bf16 v[112:127], a[184:187], v[40:43], v[112:127]
    v_cvt_pk_bf16_f32 v161, v66, v67
    v_cvt_pk_bf16_f32 v162, v68, v69
    v_cvt_pk_bf16_f32 v163, v70, v71
    s_nop 0
    v_permlane32_swap_b32 v160, v162
    v_permlane32_swap_b32 v161, v163
    v_mfma_f32_32x32x16_bf16 v[96:111], a[76:79], v[44:47], v[96:111]
    ds_write_b128 v7, v[160:163] offset:0
    v_mul_f32 v56, v80, v48
    v_mul_f32 v57, v81, v48
    v_mul_f32 v58, v82, v48
    v_mfma_f32_32x32x16_bf16 v[112:127], a[188:191], v[44:47], v[112:127]
    v_mul_f32 v59, v83, v48
    v_mul_f32 v60, v84, v48
    v_mul_f32 v61, v85, v48
    v_mul_f32 v62, v86, v48
    v_mul_f32 v63, v87, v48
    s_waitcnt lgkmcnt(1)
    v_mfma_f32_32x32x16_bf16 v[96:111], a[80:83], v[16:19], v[96:111]
    ds_read_b64_tr_b16 v[32:33], v3 offset:49152
    ds_read_b64_tr_b16 v[34:35], v3 offset:49664
    v_exp_f32 v56, v56
    v_mfma_f32_32x32x16_bf16 v[112:127], a[192:195], v[16:19], v[112:127]
    ds_read_b64_tr_b16 v[36:37], v3 offset:51200
    ds_read_b64_tr_b16 v[38:39], v3 offset:51712
    v_exp_f32 v57, v57
    v_exp_f32 v58, v58
    v_mfma_f32_32x32x16_bf16 v[96:111], a[84:87], v[20:23], v[96:111]
    ds_read_b64_tr_b16 v[40:41], v3 offset:53248
    ds_read_b64_tr_b16 v[42:43], v3 offset:53760
    v_exp_f32 v59, v59
    v_exp_f32 v60, v60
    v_mfma_f32_32x32x16_bf16 v[112:127], a[196:199], v[20:23], v[112:127]
    ds_read_b64_tr_b16 v[44:45], v3 offset:55296
    ds_read_b64_tr_b16 v[46:47], v3 offset:55808
    v_exp_f32 v61, v61
    v_mfma_f32_32x32x16_bf16 v[96:111], a[88:91], v[24:27], v[96:111]
    v_exp_f32 v62, v62
    v_exp_f32 v63, v63
    v_mul_f32 v80, v80, v88
    v_mul_f32 v81, v81, v89
    v_mfma_f32_32x32x16_bf16 v[112:127], a[200:203], v[24:27], v[112:127]
    v_mul_f32 v82, v82, v90
    v_mul_f32 v83, v83, v91
    v_mul_f32 v84, v84, v92
    v_mul_f32 v85, v85, v93
    v_mul_f32 v86, v86, v94
    v_mfma_f32_32x32x16_bf16 v[96:111], a[92:95], v[28:31], v[96:111]
    v_mul_f32 v87, v87, v95
    v_fma_f32 v56, v56, v50, v50
    v_fma_f32 v57, v57, v50, v50
    v_fma_f32 v58, v58, v50, v50
    v_mfma_f32_32x32x16_bf16 v[112:127], a[204:207], v[28:31], v[112:127]
    v_fma_f32 v59, v59, v50, v50
    v_fma_f32 v60, v60, v50, v50
    v_fma_f32 v61, v61, v50, v50
    v_fma_f32 v62, v62, v50, v50
    v_fma_f32 v63, v63, v50, v50
    s_waitcnt vmcnt(0)
    s_barrier
    s_waitcnt lgkmcnt(0)
    v_mfma_f32_32x32x16_bf16 v[96:111], a[96:99], v[32:35], v[96:111]
    ds_read_b64_tr_b16 v[16:17], v12 offset:0
    ds_read_b64_tr_b16 v[18:19], v12 offset:512
    v_rcp_f32 v56, v56
    v_mfma_f32_32x32x16_bf16 v[112:127], a[208:211], v[32:35], v[112:127]
    ds_read_b64_tr_b16 v[20:21], v12 offset:2048
    ds_read_b64_tr_b16 v[22:23], v12 offset:2560
    v_rcp_f32 v57, v57
    v_rcp_f32 v58, v58
    v_mfma_f32_32x32x16_bf16 v[96:111], a[100:103], v[36:39], v[96:111]
    ds_read_b64_tr_b16 v[24:25], v12 offset:4096
    ds_read_b64_tr_b16 v[26:27], v12 offset:4608
    v_rcp_f32 v59, v59
    v_rcp_f32 v60, v60
    v_mfma_f32_32x32x16_bf16 v[112:127], a[212:215], v[36:39], v[112:127]
    ds_read_b64_tr_b16 v[28:29], v12 offset:6144
    ds_read_b64_tr_b16 v[30:31], v12 offset:6656
    v_rcp_f32 v61, v61
    v_rcp_f32 v62, v62
    v_mfma_f32_32x32x16_bf16 v[96:111], a[104:107], v[40:43], v[96:111]
    ds_read_b64_tr_b16 v[128:129], v15 offset:0
    ds_read_b64_tr_b16 v[130:131], v15 offset:512
    v_rcp_f32 v63, v63
    v_mul_f32 v80, v80, v56
    v_mul_f32 v81, v81, v57
    v_mfma_f32_32x32x16_bf16 v[112:127], a[216:219], v[40:43], v[112:127]
    ds_read_b64_tr_b16 v[132:133], v15 offset:4096
    ds_read_b64_tr_b16 v[134:135], v15 offset:4608
    v_mul_f32 v82, v82, v58
    v_mul_f32 v83, v83, v59
    v_mul_f32 v84, v84, v60
    v_mfma_f32_32x32x16_bf16 v[96:111], a[108:111], v[44:47], v[96:111]
    v_mul_f32 v85, v85, v61
    v_mul_f32 v86, v86, v62
    v_mul_f32 v87, v87, v63
    v_cvt_pk_bf16_f32 v164, v80, v81
    v_cvt_pk_bf16_f32 v165, v82, v83
    v_mfma_f32_32x32x16_bf16 v[112:127], a[220:223], v[44:47], v[112:127]
    v_cvt_pk_bf16_f32 v166, v84, v85
    v_cvt_pk_bf16_f32 v167, v86, v87
    s_nop 0
    v_permlane32_swap_b32 v164, v166
    v_permlane32_swap_b32 v165, v167
    ds_write_b128 v10, v[164:167] offset:0
    s_waitcnt lgkmcnt(1)
    v_mfma_f32_32x32x16_bf16 v[64:79], a[0:3], v[16:19], 0
    ds_read_b64_tr_b16 v[32:33], v12 offset:8192
    ds_read_b64_tr_b16 v[34:35], v12 offset:8704
    v_mfma_f32_32x32x16_bf16 v[80:95], a[112:115], v[16:19], 0
    ds_read_b64_tr_b16 v[36:37], v12 offset:10240
    ds_read_b64_tr_b16 v[38:39], v12 offset:10752
    v_mfma_f32_16x16x32_bf16 v[148:151], v[128:131], v[128:131], 0
    ds_read_b64_tr_b16 v[40:41], v12 offset:12288
    ds_read_b64_tr_b16 v[42:43], v12 offset:12800
    v_mfma_f32_32x32x16_bf16 v[64:79], a[4:7], v[20:23], v[64:79]
    ds_read_b64_tr_b16 v[44:45], v12 offset:14336
    ds_read_b64_tr_b16 v[46:47], v12 offset:14848
    v_mfma_f32_32x32x16_bf16 v[80:95], a[116:119], v[20:23], v[80:95]
    ds_read_b64_tr_b16 v[136:137], v15 offset:8192
    ds_read_b64_tr_b16 v[138:139], v15 offset:8704
    v_mfma_f32_16x16x32_bf16 v[144:147], a[232:235], v[128:131], 0
    ds_read_b64_tr_b16 v[140:141], v15 offset:12288
    ds_read_b64_tr_b16 v[142:143], v15 offset:12800
    v_mfma_f32_32x32x16_bf16 v[64:79], a[8:11], v[24:27], v[64:79]
    buffer_load_dword v248, v246, s[44:47], 0 offen
    v_mfma_f32_32x32x16_bf16 v[80:95], a[120:123], v[24:27], v[80:95]
    v_mfma_f32_16x16x32_bf16 v[148:151], v[132:135], v[132:135], v[148:151]
    v_mfma_f32_32x32x16_bf16 v[64:79], a[12:15], v[28:31], v[64:79]
    v_mfma_f32_32x32x16_bf16 v[80:95], a[124:127], v[28:31], v[80:95]
    buffer_load_dword v249, v247, s[44:47], 0 offen
    v_mfma_f32_16x16x32_bf16 v[144:147], a[232:235], v[132:135], v[144:147]
    s_waitcnt lgkmcnt(12)
    s_barrier
    s_waitcnt lgkmcnt(0)
    v_mfma_f32_32x32x16_bf16 v[64:79], a[16:19], v[32:35], v[64:79]
    ds_read_b64_tr_b16 v[16:17], v12 offset:16384
    ds_read_b64_tr_b16 v[18:19], v12 offset:16896
    ds_read_b64_tr_b16 v[20:21], v12 offset:18432
    ds_read_b128 v[176:179], v8 offset:0
    v_mfma_f32_32x32x16_bf16 v[80:95], a[128:131], v[32:35], v[80:95]
    ds_read_b64_tr_b16 v[22:23], v12 offset:18944
    ds_read_b64_tr_b16 v[24:25], v12 offset:20480
    ds_read_b64_tr_b16 v[26:27], v12 offset:20992
    ds_read_b128 v[180:183], v11 offset:1024
    v_mfma_f32_16x16x32_bf16 v[148:151], v[136:139], v[136:139], v[148:151]
    ds_read_b64_tr_b16 v[28:29], v12 offset:22528
    ds_read_b64_tr_b16 v[30:31], v12 offset:23040
    ds_read_b64_tr_b16 v[128:129], v15 offset:16384
    v_mfma_f32_32x32x16_bf16 v[64:79], a[20:23], v[36:39], v[64:79]
    ds_read_b64_tr_b16 v[130:131], v15 offset:16896
    ds_read_b64_tr_b16 v[132:133], v15 offset:20480
    ds_read_b64_tr_b16 v[134:135], v15 offset:20992
    v_mfma_f32_32x32x16_bf16 v[80:95], a[132:135], v[36:39], v[80:95]
    s_mov_b32 s52, 0
    s_waitcnt lgkmcnt(10)
    buffer_store_dwordx4 v[176:179], v9, s[40:43], s52 offen sc0 sc1
    v_mfma_f32_16x16x32_bf16 v[144:147], a[232:235], v[136:139], v[144:147]
    s_mov_b32 s52, 14848
    s_waitcnt lgkmcnt(6)
    buffer_store_dwordx4 v[180:183], v9, s[40:43], s52 offen sc0 sc1
    v_mfma_f32_32x32x16_bf16 v[96:111], a[224:227], v[156:159], v[96:111]
    v_mfma_f32_32x32x16_bf16 v[112:127], a[228:231], v[156:159], v[112:127]
    v_mfma_f32_32x32x16_bf16 v[64:79], a[24:27], v[40:43], v[64:79]
    v_mfma_f32_32x32x16_bf16 v[80:95], a[136:139], v[40:43], v[80:95]
    v_mfma_f32_16x16x32_bf16 v[148:151], v[140:143], v[140:143], v[148:151]
    v_mfma_f32_32x32x16_bf16 v[64:79], a[28:31], v[44:47], v[64:79]
    s_nop 6
    v_mul_f32 v56, v96, v52
    v_mul_f32 v57, v97, v52
    v_mfma_f32_32x32x16_bf16 v[80:95], a[140:143], v[44:47], v[80:95]
    v_mul_f32 v58, v98, v52
    v_mul_f32 v59, v99, v52
    v_mul_f32 v60, v100, v52
    v_mfma_f32_16x16x32_bf16 v[144:147], a[232:235], v[140:143], v[144:147]
    v_mul_f32 v61, v101, v52
    s_waitcnt lgkmcnt(0)
    v_mfma_f32_32x32x16_bf16 v[64:79], a[32:35], v[16:19], v[64:79]
    ds_read_b64_tr_b16 v[32:33], v12 offset:24576
    ds_read_b64_tr_b16 v[34:35], v12 offset:25088
    v_mul_f32 v62, v102, v52
    v_mul_f32 v63, v103, v52
    v_mfma_f32_32x32x16_bf16 v[80:95], a[144:147], v[16:19], v[80:95]
    ds_read_b64_tr_b16 v[36:37], v12 offset:26624
    ds_read_b64_tr_b16 v[38:39], v12 offset:27136
    v_exp_f32 v56, v56
    v_mfma_f32_16x16x32_bf16 v[148:151], v[128:131], v[128:131], v[148:151]
    ds_read_b64_tr_b16 v[40:41], v12 offset:28672
    ds_read_b64_tr_b16 v[42:43], v12 offset:29184
    v_mfma_f32_32x32x16_bf16 v[64:79], a[36:39], v[20:23], v[64:79]
    ds_read_b64_tr_b16 v[44:45], v12 offset:30720
    ds_read_b64_tr_b16 v[46:47], v12 offset:31232
    v_exp_f32 v57, v57
    v_mfma_f32_32x32x16_bf16 v[80:95], a[148:151], v[20:23], v[80:95]
    ds_read_b64_tr_b16 v[136:137], v15 offset:24576
    ds_read_b64_tr_b16 v[138:139], v15 offset:25088
    v_exp_f32 v58, v58
    v_exp_f32 v59, v59
    v_mfma_f32_16x16x32_bf16 v[144:147], a[232:235], v[128:131], v[144:147]
    ds_read_b64_tr_b16 v[140:141], v15 offset:28672
    ds_read_b64_tr_b16 v[142:143], v15 offset:29184
    v_mfma_f32_32x32x16_bf16 v[64:79], a[40:43], v[24:27], v[64:79]
    v_exp_f32 v60, v60
    v_exp_f32 v61, v61
    v_mfma_f32_32x32x16_bf16 v[80:95], a[152:155], v[24:27], v[80:95]
    v_exp_f32 v62, v62
    v_exp_f32 v63, v63
    v_mfma_f32_16x16x32_bf16 v[148:151], v[132:135], v[132:135], v[148:151]
    v_mul_f32 v96, v96, v104
    v_mfma_f32_32x32x16_bf16 v[64:79], a[44:47], v[28:31], v[64:79]
    v_mul_f32 v97, v97, v105
    v_mul_f32 v98, v98, v106
    v_mul_f32 v99, v99, v107
    v_mfma_f32_32x32x16_bf16 v[80:95], a[156:159], v[28:31], v[80:95]
    v_mul_f32 v100, v100, v108
    v_mul_f32 v101, v101, v109
    v_mul_f32 v102, v102, v110
    v_mul_f32 v103, v103, v111
    v_mfma_f32_16x16x32_bf16 v[144:147], a[232:235], v[132:135], v[144:147]
    v_fma_f32 v56, v56, v54, v54
    s_waitcnt lgkmcnt(0)
    v_mfma_f32_32x32x16_bf16 v[64:79], a[48:51], v[32:35], v[64:79]
    ds_read_b64_tr_b16 v[16:17], v12 offset:32768
    ds_read_b64_tr_b16 v[18:19], v12 offset:33280
    v_fma_f32 v57, v57, v54, v54
    v_fma_f32 v58, v58, v54, v54
    v_mfma_f32_32x32x16_bf16 v[80:95], a[160:163], v[32:35], v[80:95]
    ds_read_b64_tr_b16 v[20:21], v12 offset:34816
    ds_read_b64_tr_b16 v[22:23], v12 offset:35328
    v_fma_f32 v59, v59, v54, v54
    v_fma_f32 v60, v60, v54, v54
    v_fma_f32 v61, v61, v54, v54
    v_mfma_f32_16x16x32_bf16 v[148:151], v[136:139], v[136:139], v[148:151]
    ds_read_b64_tr_b16 v[24:25], v12 offset:36864
    ds_read_b64_tr_b16 v[26:27], v12 offset:37376
    v_mfma_f32_32x32x16_bf16 v[64:79], a[52:55], v[36:39], v[64:79]
    ds_read_b64_tr_b16 v[28:29], v12 offset:38912
    ds_read_b64_tr_b16 v[30:31], v12 offset:39424
    v_fma_f32 v62, v62, v54, v54
    v_fma_f32 v63, v63, v54, v54
    v_mfma_f32_32x32x16_bf16 v[80:95], a[164:167], v[36:39], v[80:95]
    ds_read_b64_tr_b16 v[128:129], v15 offset:32768
    ds_read_b64_tr_b16 v[130:131], v15 offset:33280
    v_rcp_f32 v56, v56
    v_mfma_f32_16x16x32_bf16 v[144:147], a[232:235], v[136:139], v[144:147]
    ds_read_b64_tr_b16 v[132:133], v15 offset:36864
    ds_read_b64_tr_b16 v[134:135], v15 offset:37376
    v_mfma_f32_32x32x16_bf16 v[64:79], a[56:59], v[40:43], v[64:79]
    v_rcp_f32 v57, v57
    v_rcp_f32 v58, v58
    v_mfma_f32_32x32x16_bf16 v[80:95], a[168:171], v[40:43], v[80:95]
    v_rcp_f32 v59, v59
    v_rcp_f32 v60, v60
    v_mfma_f32_16x16x32_bf16 v[148:151], v[140:143], v[140:143], v[148:151]
    v_rcp_f32 v61, v61
    v_mfma_f32_32x32x16_bf16 v[64:79], a[60:63], v[44:47], v[64:79]
    v_rcp_f32 v62, v62
    v_rcp_f32 v63, v63
    v_mfma_f32_32x32x16_bf16 v[80:95], a[172:175], v[44:47], v[80:95]
    v_mul_f32 v96, v96, v56
    v_mul_f32 v97, v97, v57
    v_mul_f32 v98, v98, v58
    v_mul_f32 v99, v99, v59
    v_mfma_f32_16x16x32_bf16 v[144:147], a[232:235], v[140:143], v[144:147]
    v_mul_f32 v100, v100, v60
    s_waitcnt lgkmcnt(0)
    v_mfma_f32_32x32x16_bf16 v[64:79], a[64:67], v[16:19], v[64:79]
    ds_read_b64_tr_b16 v[32:33], v12 offset:40960
    ds_read_b64_tr_b16 v[34:35], v12 offset:41472
    v_mul_f32 v101, v101, v61
    v_mul_f32 v102, v102, v62
    v_mfma_f32_32x32x16_bf16 v[80:95], a[176:179], v[16:19], v[80:95]
    ds_read_b64_tr_b16 v[36:37], v12 offset:43008
    ds_read_b64_tr_b16 v[38:39], v12 offset:43520
    v_mul_f32 v103, v103, v63
    v_cvt_pk_bf16_f32 v160, v96, v97
    v_mfma_f32_16x16x32_bf16 v[148:151], v[128:131], v[128:131], v[148:151]
    ds_read_b64_tr_b16 v[40:41], v12 offset:45056
    ds_read_b64_tr_b16 v[42:43], v12 offset:45568
    v_mfma_f32_32x32x16_bf16 v[64:79], a[68:71], v[20:23], v[64:79]
    ds_read_b64_tr_b16 v[44:45], v12 offset:47104
    ds_read_b64_tr_b16 v[46:47], v12 offset:47616
    v_cvt_pk_bf16_f32 v161, v98, v99
    v_cvt_pk_bf16_f32 v162, v100, v101
    v_cvt_pk_bf16_f32 v163, v102, v103
    v_mfma_f32_32x32x16_bf16 v[80:95], a[180:183], v[20:23], v[80:95]
    ds_read_b64_tr_b16 v[136:137], v15 offset:40960
    ds_read_b64_tr_b16 v[138:139], v15 offset:41472
    v_permlane32_swap_b32 v160, v162
    v_permlane32_swap_b32 v161, v163
    v_mfma_f32_16x16x32_bf16 v[144:147], a[232:235], v[128:131], v[144:147]
    ds_read_b64_tr_b16 v[140:141], v15 offset:45056
    ds_read_b64_tr_b16 v[142:143], v15 offset:45568
    v_mfma_f32_32x32x16_bf16 v[64:79], a[72:75], v[24:27], v[64:79]
    ds_write_b128 v7, v[160:163] offset:8192
    v_mul_f32 v56, v112, v52
    v_mul_f32 v57, v113, v52
    v_mfma_f32_32x32x16_bf16 v[80:95], a[184:187], v[24:27], v[80:95]
    v_mul_f32 v58, v114, v52
    v_mul_f32 v59, v115, v52
    v_mul_f32 v60, v116, v52
    v_mul_f32 v61, v117, v52
    v_mfma_f32_16x16x32_bf16 v[148:151], v[132:135], v[132:135], v[148:151]
    v_mul_f32 v62, v118, v52
    v_mfma_f32_32x32x16_bf16 v[64:79], a[76:79], v[28:31], v[64:79]
    v_mul_f32 v63, v119, v52
    v_exp_f32 v56, v56
    v_mfma_f32_32x32x16_bf16 v[80:95], a[188:191], v[28:31], v[80:95]
    v_exp_f32 v57, v57
    v_exp_f32 v58, v58
    v_mfma_f32_16x16x32_bf16 v[144:147], a[232:235], v[132:135], v[144:147]
    v_exp_f32 v59, v59
    s_waitcnt lgkmcnt(1)
    v_mfma_f32_32x32x16_bf16 v[64:79], a[80:83], v[32:35], v[64:79]
    ds_read_b64_tr_b16 v[16:17], v12 offset:49152
    ds_read_b64_tr_b16 v[18:19], v12 offset:49664
    v_exp_f32 v60, v60
    v_mfma_f32_32x32x16_bf16 v[80:95], a[192:195], v[32:35], v[80:95]
    ds_read_b64_tr_b16 v[20:21], v12 offset:51200
    ds_read_b64_tr_b16 v[22:23], v12 offset:51712
    v_exp_f32 v61, v61
    v_mfma_f32_16x16x32_bf16 v[148:151], v[136:139], v[136:139], v[148:151]
    ds_read_b64_tr_b16 v[24:25], v12 offset:53248
    ds_read_b64_tr_b16 v[26:27], v12 offset:53760
    v_mfma_f32_32x32x16_bf16 v[64:79], a[84:87], v[36:39], v[64:79]
    ds_read_b64_tr_b16 v[28:29], v12 offset:55296
    ds_read_b64_tr_b16 v[30:31], v12 offset:55808
    v_exp_f32 v62, v62
    v_exp_f32 v63, v63
    v_mfma_f32_32x32x16_bf16 v[80:95], a[196:199], v[36:39], v[80:95]
    ds_read_b64_tr_b16 v[128:129], v15 offset:49152
    ds_read_b64_tr_b16 v[130:131], v15 offset:49664
    v_mul_f32 v112, v112, v120
    v_mul_f32 v113, v113, v121
    v_mfma_f32_16x16x32_bf16 v[144:147], a[232:235], v[136:139], v[144:147]
    ds_read_b64_tr_b16 v[132:133], v15 offset:53248
    ds_read_b64_tr_b16 v[134:135], v15 offset:53760
    v_mfma_f32_32x32x16_bf16 v[64:79], a[88:91], v[40:43], v[64:79]
    v_mul_f32 v114, v114, v122
    v_mul_f32 v115, v115, v123
    v_mul_f32 v116, v116, v124
    v_mul_f32 v117, v117, v125
    v_mfma_f32_32x32x16_bf16 v[80:95], a[200:203], v[40:43], v[80:95]
    v_mul_f32 v118, v118, v126
    v_mul_f32 v119, v119, v127
    v_fma_f32 v56, v56, v54, v54
    v_fma_f32 v57, v57, v54, v54
    v_mfma_f32_16x16x32_bf16 v[148:151], v[140:143], v[140:143], v[148:151]
    v_fma_f32 v58, v58, v54, v54
    v_mfma_f32_32x32x16_bf16 v[64:79], a[92:95], v[44:47], v[64:79]
    v_fma_f32 v59, v59, v54, v54
    v_fma_f32 v60, v60, v54, v54
    v_fma_f32 v61, v61, v54, v54
    v_fma_f32 v62, v62, v54, v54
    v_mfma_f32_32x32x16_bf16 v[80:95], a[204:207], v[44:47], v[80:95]
    v_fma_f32 v63, v63, v54, v54
    v_rcp_f32 v56, v56
    v_mfma_f32_16x16x32_bf16 v[144:147], a[232:235], v[140:143], v[144:147]
    v_rcp_f32 v57, v57
    s_waitcnt lgkmcnt(0)
    v_mfma_f32_32x32x16_bf16 v[64:79], a[96:99], v[16:19], v[64:79]
    ds_read_b64_tr_b16 v[32:33], v13 offset:0
    v_rcp_f32 v58, v58
    v_mfma_f32_32x32x16_bf16 v[80:95], a[208:211], v[16:19], v[80:95]
    ds_read_b64_tr_b16 v[34:35], v13 offset:512
    v_rcp_f32 v59, v59
    v_rcp_f32 v60, v60
    v_mfma_f32_16x16x32_bf16 v[148:151], v[128:131], v[128:131], v[148:151]
    ds_read_b64_tr_b16 v[36:37], v13 offset:2048
    v_mfma_f32_32x32x16_bf16 v[64:79], a[100:103], v[20:23], v[64:79]
    ds_read_b64_tr_b16 v[38:39], v13 offset:2560
    v_rcp_f32 v61, v61
    v_mfma_f32_32x32x16_bf16 v[80:95], a[212:215], v[20:23], v[80:95]
    ds_read_b64_tr_b16 v[40:41], v13 offset:4096
    v_rcp_f32 v62, v62
    v_rcp_f32 v63, v63
    v_mfma_f32_16x16x32_bf16 v[144:147], a[232:235], v[128:131], v[144:147]
    ds_read_b64_tr_b16 v[42:43], v13 offset:4608
    v_mul_f32 v112, v112, v56
    v_mfma_f32_32x32x16_bf16 v[64:79], a[104:107], v[24:27], v[64:79]
    ds_read_b64_tr_b16 v[44:45], v13 offset:6144
    v_mul_f32 v113, v113, v57
    v_mul_f32 v114, v114, v58
    v_mfma_f32_32x32x16_bf16 v[80:95], a[216:219], v[24:27], v[80:95]
    ds_read_b64_tr_b16 v[46:47], v13 offset:6656
    v_mul_f32 v115, v115, v59
    v_mul_f32 v116, v116, v60
    v_mul_f32 v117, v117, v61
    v_mfma_f32_16x16x32_bf16 v[148:151], v[132:135], v[132:135], v[148:151]
    v_mul_f32 v118, v118, v62
    v_mfma_f32_32x32x16_bf16 v[64:79], a[108:111], v[28:31], v[64:79]
    v_mul_f32 v119, v119, v63
    v_cvt_pk_bf16_f32 v164, v112, v113
    v_cvt_pk_bf16_f32 v165, v114, v115
    v_mfma_f32_32x32x16_bf16 v[80:95], a[220:223], v[28:31], v[80:95]
    v_cvt_pk_bf16_f32 v166, v116, v117
    v_cvt_pk_bf16_f32 v167, v118, v119
    s_nop 0
    v_permlane32_swap_b32 v164, v166
    v_permlane32_swap_b32 v165, v167
    v_mfma_f32_16x16x32_bf16 v[144:147], a[232:235], v[132:135], v[144:147]
    ds_write_b128 v10, v[164:167] offset:8192
    v_cndmask_b32 v148, v148, v149, s[82:83]
    v_cndmask_b32 v150, v150, v151, s[82:83]
    s_nop 4
    v_cndmask_b32 v145, v148, v150, s[84:85]
    s_mov_b64 s[88:89], exec
    s_mov_b64 exec, s[80:81]
    ds_write_b64 v5, v[144:145] offset:512
    s_mov_b64 exec, s[88:89]
    s_waitcnt lgkmcnt(2)
    v_mfma_f32_32x32x16_bf16 v[96:111], a[0:3], v[32:35], 0
    ds_read_b64_tr_b16 v[16:17], v13 offset:8192
    ds_read_b64_tr_b16 v[18:19], v13 offset:8704
    v_mfma_f32_32x32x16_bf16 v[112:127], a[112:115], v[32:35], 0
    ds_read_b64_tr_b16 v[20:21], v13 offset:10240
    ds_read_b64_tr_b16 v[22:23], v13 offset:10752
    v_mfma_f32_32x32x16_bf16 v[96:111], a[4:7], v[36:39], v[96:111]
    ds_read_b64_tr_b16 v[24:25], v13 offset:12288
    ds_read_b64_tr_b16 v[26:27], v13 offset:12800
    v_mfma_f32_32x32x16_bf16 v[112:127], a[116:119], v[36:39], v[112:127]
    ds_read_b64_tr_b16 v[28:29], v13 offset:14336
    ds_read_b64_tr_b16 v[30:31], v13 offset:14848
    v_mfma_f32_32x32x16_bf16 v[96:111], a[8:11], v[40:43], v[96:111]
    v_mfma_f32_32x32x16_bf16 v[112:127], a[120:123], v[40:43], v[112:127]
    v_mfma_f32_32x32x16_bf16 v[96:111], a[12:15], v[44:47], v[96:111]
    v_mfma_f32_32x32x16_bf16 v[112:127], a[124:127], v[44:47], v[112:127]
    s_waitcnt lgkmcnt(8)
    s_barrier
    s_waitcnt lgkmcnt(0)
    v_mfma_f32_32x32x16_bf16 v[96:111], a[16:19], v[16:19], v[96:111]
    ds_read_b64_tr_b16 v[32:33], v13 offset:16384
    ds_read_b64_tr_b16 v[34:35], v13 offset:16896
    ds_read_b128 v[176:179], v8 offset:8192
    ds_read_b128 v[180:183], v11 offset:9216
    v_mfma_f32_32x32x16_bf16 v[112:127], a[128:131], v[16:19], v[112:127]
    ds_read_b64_tr_b16 v[36:37], v13 offset:18432
    ds_read_b64_tr_b16 v[38:39], v13 offset:18944
    s_mov_b32 s52, 118784
    s_waitcnt lgkmcnt(3)
    buffer_store_dwordx4 v[176:179], v9, s[40:43], s52 offen sc0 sc1
    v_mfma_f32_32x32x16_bf16 v[96:111], a[20:23], v[20:23], v[96:111]
    ds_read_b64_tr_b16 v[40:41], v13 offset:20480
    ds_read_b64_tr_b16 v[42:43], v13 offset:20992
    s_mov_b32 s52, 133632
    s_waitcnt lgkmcnt(4)
    buffer_store_dwordx4 v[180:183], v9, s[40:43], s52 offen sc0 sc1
    ds_read_b64 v[168:169], v6 offset:512
    v_mfma_f32_32x32x16_bf16 v[112:127], a[132:135], v[20:23], v[112:127]
    ds_read_b64_tr_b16 v[44:45], v13 offset:22528
    ds_read_b64_tr_b16 v[46:47], v13 offset:23040
    s_waitcnt lgkmcnt(2)
    v_mul_f32 v168, 0x3b124925, v168
    v_mul_f32 v169, 0x3b124925, v169
    v_fma_f32 v169, -v168, v168, v169
    v_max_f32 v169, 0, v169
    v_mfma_f32_32x32x16_bf16 v[96:111], a[24:27], v[24:27], v[96:111]
    v_cvt_pk_bf16_f32 v172, -v168, v169
    v_and_b32 v169, 0xffff0000, v172
    v_add_f32 v169, 0x3727c5ac, v169
    v_cvt_pk_bf16_f32 v169, v169, v169
    v_mfma_f32_32x32x16_bf16 v[112:127], a[136:139], v[24:27], v[112:127]
    v_lshlrev_b32 v169, 16, v169
    v_sqrt_f32 v169, v169
    v_and_b32 v172, 0xffff, v172
    v_cvt_pk_bf16_f32 v169, v169, v169
    v_mfma_f32_32x32x16_bf16 v[96:111], a[28:31], v[28:31], v[96:111]
    v_lshlrev_b32 v169, 16, v169
    v_lshl_or_b32 v172, v172, 16, v172
    v_rcp_f32 v173, v169
    v_mul_f32 v174, v169, v169
    v_mfma_f32_32x32x16_bf16 v[112:127], a[140:143], v[28:31], v[112:127]
    v_mul_f32 v173, 0xbfb8aa3b, v173
    v_mov_b32 v152, v172
    v_mov_b32 v156, v172
    s_nop 1
    v_permlane32_swap_b32 v152, v156
    v_mov_b32 v48, v173
    s_waitcnt lgkmcnt(0)
    v_mfma_f32_32x32x16_bf16 v[96:111], a[32:35], v[32:35], v[96:111]
    ds_read_b64_tr_b16 v[16:17], v13 offset:24576
    ds_read_b64_tr_b16 v[18:19], v13 offset:25088
    ds_read_b64_tr_b16 v[20:21], v13 offset:26624
    ds_read_b64_tr_b16 v[22:23], v13 offset:27136
    ds_read_b64_tr_b16 v[24:25], v13 offset:28672
    ds_read_b64_tr_b16 v[26:27], v13 offset:29184
    v_mfma_f32_32x32x16_bf16 v[112:127], a[144:147], v[32:35], v[112:127]
    v_mov_b32 v52, v173
    s_nop 1
    v_permlane32_swap_b32 v48, v52
    v_mov_b32 v50, v174
    v_mfma_f32_32x32x16_bf16 v[96:111], a[36:39], v[36:39], v[96:111]
    v_mov_b32 v54, v174
    s_nop 1
    v_permlane32_swap_b32 v50, v54
    v_cndmask_b32 v152, 0, v152, s[86:87]
    v_cndmask_b32 v156, 0, v156, s[86:87]
    s_nop 0
    v_mfma_f32_32x32x16_bf16 v[64:79], a[224:227], v[152:155], v[64:79]
    ds_read_b64_tr_b16 v[28:29], v13 offset:30720
    v_mfma_f32_32x32x16_bf16 v[80:95], a[228:231], v[152:155], v[80:95]
    ds_read_b64_tr_b16 v[30:31], v13 offset:31232
    v_mfma_f32_32x32x16_bf16 v[112:127], a[148:151], v[36:39], v[112:127]
    v_mfma_f32_32x32x16_bf16 v[96:111], a[40:43], v[40:43], v[96:111]
    v_mfma_f32_32x32x16_bf16 v[112:127], a[152:155], v[40:43], v[112:127]
    v_mfma_f32_32x32x16_bf16 v[96:111], a[44:47], v[44:47], v[96:111]
    s_nop 4
    v_mul_f32 v56, v64, v48
    v_mul_f32 v57, v65, v48
    v_mul_f32 v58, v66, v48
    v_mul_f32 v59, v67, v48
    v_mul_f32 v60, v68, v48
    v_mul_f32 v61, v69, v48
    v_mfma_f32_32x32x16_bf16 v[112:127], a[156:159], v[44:47], v[112:127]
    v_mul_f32 v62, v70, v48
    v_mul_f32 v63, v71, v48
    v_exp_f32 v56, v56
    v_exp_f32 v57, v57
    s_waitcnt lgkmcnt(0)
    v_mfma_f32_32x32x16_bf16 v[96:111], a[48:51], v[16:19], v[96:111]
    ds_read_b64_tr_b16 v[32:33], v13 offset:32768
    ds_read_b64_tr_b16 v[34:35], v13 offset:33280
    s_add_u32 m0, s57, 0
    s_mov_b32 s52, 0
    buffer_load_dwordx4 v184, s[44:47], s52 offen offset:0 lds
    v_mfma_f32_32x32x16_bf16 v[112:127], a[160:163], v[16:19], v[112:127]
    ds_read_b64_tr_b16 v[36:37], v13 offset:34816
    ds_read_b64_tr_b16 v[38:39], v13 offset:35328
    v_exp_f32 v58, v58
    v_exp_f32 v59, v59
    v_mfma_f32_32x32x16_bf16 v[96:111], a[52:55], v[20:23], v[96:111]
    ds_read_b64_tr_b16 v[40:41], v13 offset:36864
    ds_read_b64_tr_b16 v[42:43], v13 offset:37376
    v_exp_f32 v60, v60
    v_exp_f32 v61, v61
    v_exp_f32 v62, v62
    v_mfma_f32_32x32x16_bf16 v[112:127], a[164:167], v[20:23], v[112:127]
    ds_read_b64_tr_b16 v[44:45], v13 offset:38912
    ds_read_b64_tr_b16 v[46:47], v13 offset:39424
    v_exp_f32 v63, v63
    v_mfma_f32_32x32x16_bf16 v[96:111], a[56:59], v[24:27], v[96:111]
    s_mov_b32 s52, 6144
    buffer_load_dwordx4 v184, s[44:47], s52 offen offset:1024 lds
    v_mul_f32 v64, v64, v72
    v_mul_f32 v65, v65, v73
    v_mul_f32 v66, v66, v74
    v_mul_f32 v67, v67, v75
    v_mul_f32 v68, v68, v76
    v_mul_f32 v69, v69, v77
    v_mfma_f32_32x32x16_bf16 v[112:127], a[168:171], v[24:27], v[112:127]
    s_mov_b32 s52, 12288
    buffer_load_dwordx4 v184, s[44:47], s52 offen offset:2048 lds
    v_mul_f32 v70, v70, v78
    v_mul_f32 v71, v71, v79
    v_fma_f32 v56, v56, v50, v50
    v_mfma_f32_32x32x16_bf16 v[96:111], a[60:63], v[28:31], v[96:111]
    v_fma_f32 v57, v57, v50, v50
    v_fma_f32 v58, v58, v50, v50
    v_fma_f32 v59, v59, v50, v50
    s_mov_b32 s52, 18432
    buffer_load_dwordx4 v184, s[44:47], s52 offen offset:3072 lds
    v_fma_f32 v60, v60, v50, v50
    v_mfma_f32_32x32x16_bf16 v[112:127], a[172:175], v[28:31], v[112:127]
    v_fma_f32 v61, v61, v50, v50
    v_fma_f32 v62, v62, v50, v50
    v_fma_f32 v63, v63, v50, v50
    v_rcp_f32 v56, v56
    v_rcp_f32 v57, v57
    s_waitcnt lgkmcnt(0)
    v_mfma_f32_32x32x16_bf16 v[96:111], a[64:67], v[32:35], v[96:111]
    ds_read_b64_tr_b16 v[16:17], v13 offset:40960
    ds_read_b64_tr_b16 v[18:19], v13 offset:41472
    s_add_u32 m0, s57, 4096
    s_mov_b32 s52, 28672
    buffer_load_dwordx4 v184, s[44:47], s52 offen offset:0 lds
    v_mfma_f32_32x32x16_bf16 v[112:127], a[176:179], v[32:35], v[112:127]
    ds_read_b64_tr_b16 v[20:21], v13 offset:43008
    ds_read_b64_tr_b16 v[22:23], v13 offset:43520
    v_rcp_f32 v58, v58
    v_rcp_f32 v59, v59
    v_mfma_f32_32x32x16_bf16 v[96:111], a[68:71], v[36:39], v[96:111]
    ds_read_b64_tr_b16 v[24:25], v13 offset:45056
    ds_read_b64_tr_b16 v[26:27], v13 offset:45568
    v_rcp_f32 v60, v60
    v_rcp_f32 v61, v61
    v_rcp_f32 v62, v62
    v_mfma_f32_32x32x16_bf16 v[112:127], a[180:183], v[36:39], v[112:127]
    ds_read_b64_tr_b16 v[28:29], v13 offset:47104
    ds_read_b64_tr_b16 v[30:31], v13 offset:47616
    v_rcp_f32 v63, v63
    v_mul_f32 v64, v64, v56
    v_mfma_f32_32x32x16_bf16 v[96:111], a[72:75], v[40:43], v[96:111]
    s_mov_b32 s52, 34816
    buffer_load_dwordx4 v184, s[44:47], s52 offen offset:1024 lds
    v_mul_f32 v65, v65, v57
    v_mul_f32 v66, v66, v58
    v_mul_f32 v67, v67, v59
    v_mul_f32 v68, v68, v60
    v_mul_f32 v69, v69, v61
    v_mul_f32 v70, v70, v62
    v_mfma_f32_32x32x16_bf16 v[112:127], a[184:187], v[40:43], v[112:127]
    v_mul_f32 v71, v71, v63
    s_mov_b32 s52, 40960
    buffer_load_dwordx4 v184, s[44:47], s52 offen offset:2048 lds
    v_cvt_pk_bf16_f32 v160, v64, v65
    v_cvt_pk_bf16_f32 v161, v66, v67
    v_mfma_f32_32x32x16_bf16 v[96:111], a[76:79], v[44:47], v[96:111]
    v_cvt_pk_bf16_f32 v162, v68, v69
    v_cvt_pk_bf16_f32 v163, v70, v71
    s_nop 0
    v_permlane32_swap_b32 v160, v162
    v_permlane32_swap_b32 v161, v163
    ds_write_b128 v7, v[160:163] offset:16384
    v_mfma_f32_32x32x16_bf16 v[112:127], a[188:191], v[44:47], v[112:127]
    s_mov_b32 s52, 47104
    buffer_load_dwordx4 v184, s[44:47], s52 offen offset:3072 lds
    v_mul_f32 v56, v80, v48
    v_mul_f32 v57, v81, v48
    v_mul_f32 v58, v82, v48
    v_mul_f32 v59, v83, v48
    v_mul_f32 v60, v84, v48
    v_mul_f32 v61, v85, v48
    s_waitcnt lgkmcnt(1)
    v_mfma_f32_32x32x16_bf16 v[96:111], a[80:83], v[16:19], v[96:111]
    ds_read_b64_tr_b16 v[32:33], v13 offset:49152
    ds_read_b64_tr_b16 v[34:35], v13 offset:49664
    s_add_u32 m0, s57, 8192
    s_mov_b32 s52, 57344
    buffer_load_dwordx4 v184, s[44:47], s52 offen offset:0 lds
    v_mfma_f32_32x32x16_bf16 v[112:127], a[192:195], v[16:19], v[112:127]
    ds_read_b64_tr_b16 v[36:37], v13 offset:51200
    ds_read_b64_tr_b16 v[38:39], v13 offset:51712
    v_mul_f32 v62, v86, v48
    v_mul_f32 v63, v87, v48
    v_exp_f32 v56, v56
    v_mfma_f32_32x32x16_bf16 v[96:111], a[84:87], v[20:23], v[96:111]
    ds_read_b64_tr_b16 v[40:41], v13 offset:53248
    ds_read_b64_tr_b16 v[42:43], v13 offset:53760
    v_exp_f32 v57, v57
    v_exp_f32 v58, v58
    v_exp_f32 v59, v59
    v_mfma_f32_32x32x16_bf16 v[112:127], a[196:199], v[20:23], v[112:127]
    ds_read_b64_tr_b16 v[44:45], v13 offset:55296
    ds_read_b64_tr_b16 v[46:47], v13 offset:55808
    s_mov_b32 s52, 63488
    buffer_load_dwordx4 v184, s[44:47], s52 offen offset:1024 lds
    v_mfma_f32_32x32x16_bf16 v[96:111], a[88:91], v[24:27], v[96:111]
    v_exp_f32 v60, v60
    v_exp_f32 v61, v61
    v_exp_f32 v62, v62
    v_exp_f32 v63, v63
    v_mfma_f32_32x32x16_bf16 v[112:127], a[200:203], v[24:27], v[112:127]
    v_mul_f32 v80, v80, v88
    v_mul_f32 v81, v81, v89
    s_mov_b32 s52, 69632
    buffer_load_dwordx4 v184, s[44:47], s52 offen offset:2048 lds
    v_mul_f32 v82, v82, v90
    v_mul_f32 v83, v83, v91
    v_mfma_f32_32x32x16_bf16 v[96:111], a[92:95], v[28:31], v[96:111]
    v_mul_f32 v84, v84, v92
    v_mul_f32 v85, v85, v93
    v_mul_f32 v86, v86, v94
    v_mul_f32 v87, v87, v95
    v_mfma_f32_32x32x16_bf16 v[112:127], a[204:207], v[28:31], v[112:127]
    s_mov_b32 s52, 75776
    buffer_load_dwordx4 v184, s[44:47], s52 offen offset:3072 lds
    v_fma_f32 v56, v56, v50, v50
    v_fma_f32 v57, v57, v50, v50
    v_fma_f32 v58, v58, v50, v50
    v_fma_f32 v59, v59, v50, v50
    v_fma_f32 v60, v60, v50, v50
    v_fma_f32 v61, v61, v50, v50
    s_waitcnt lgkmcnt(0)
    v_mfma_f32_32x32x16_bf16 v[96:111], a[96:99], v[32:35], v[96:111]
    s_add_u32 m0, s57, 12288
    s_mov_b32 s52, 86016
    buffer_load_dwordx4 v184, s[44:47], s52 offen offset:0 lds
    v_mfma_f32_32x32x16_bf16 v[96:111], a[100:103], v[36:39], v[96:111]
    v_fma_f32 v62, v62, v50, v50
    v_fma_f32 v63, v63, v50, v50
    v_rcp_f32 v56, v56
    v_mfma_f32_32x32x16_bf16 v[96:111], a[104:107], v[40:43], v[96:111]
    v_rcp_f32 v57, v57
    v_rcp_f32 v58, v58
    v_rcp_f32 v59, v59
    v_mfma_f32_32x32x16_bf16 v[96:111], a[108:111], v[44:47], v[96:111]
    v_rcp_f32 v60, v60
    s_mov_b32 s52, 92160
    buffer_load_dwordx4 v184, s[44:47], s52 offen offset:1024 lds
    v_mfma_f32_32x32x16_bf16 v[96:111], a[224:227], v[156:159], v[96:111]
    v_rcp_f32 v61, v61
    v_rcp_f32 v62, v62
    v_mfma_f32_32x32x16_bf16 v[112:127], a[208:211], v[32:35], v[112:127]
    v_rcp_f32 v63, v63
    v_mul_f32 v80, v80, v56
    v_mul_f32 v81, v81, v57
    v_mul_f32 v82, v82, v58
    v_mfma_f32_32x32x16_bf16 v[112:127], a[212:215], v[36:39], v[112:127]
    s_mov_b32 s52, 98304
    buffer_load_dwordx4 v184, s[44:47], s52 offen offset:2048 lds
    v_mul_f32 v83, v83, v59
    v_mfma_f32_32x32x16_bf16 v[112:127], a[216:219], v[40:43], v[112:127]
    v_mul_f32 v84, v84, v60
    v_mul_f32 v85, v85, v61
    v_mul_f32 v86, v86, v62
    v_mul_f32 v87, v87, v63
    v_cvt_pk_bf16_f32 v164, v80, v81
    v_mfma_f32_32x32x16_bf16 v[112:127], a[220:223], v[44:47], v[112:127]
    s_mov_b32 s52, 104448
    buffer_load_dwordx4 v184, s[44:47], s52 offen offset:3072 lds
    v_cvt_pk_bf16_f32 v165, v82, v83
    v_mfma_f32_32x32x16_bf16 v[112:127], a[228:231], v[156:159], v[112:127]
    v_cvt_pk_bf16_f32 v166, v84, v85
    v_cvt_pk_bf16_f32 v167, v86, v87
    s_nop 0
    v_permlane32_swap_b32 v164, v166
    v_permlane32_swap_b32 v165, v167
    ds_write_b128 v10, v[164:167] offset:16384
    v_pk_mul_f32 v[56:57], v[96:97], v[52:53] op_sel_hi:[1,0]
    v_pk_mul_f32 v[58:59], v[98:99], v[52:53] op_sel_hi:[1,0]
    v_pk_mul_f32 v[60:61], v[100:101], v[52:53] op_sel_hi:[1,0]
    v_pk_mul_f32 v[62:63], v[102:103], v[52:53] op_sel_hi:[1,0]
    v_exp_f32 v56, v56
    v_exp_f32 v57, v57
    v_exp_f32 v58, v58
    v_exp_f32 v59, v59
    v_exp_f32 v60, v60
    v_exp_f32 v61, v61
    v_exp_f32 v62, v62
    v_exp_f32 v63, v63
    v_pk_mul_f32 v[96:97], v[96:97], v[104:105]
    v_pk_mul_f32 v[98:99], v[98:99], v[106:107]
    v_pk_mul_f32 v[100:101], v[100:101], v[108:109]
    v_pk_mul_f32 v[102:103], v[102:103], v[110:111]
    v_pk_fma_f32 v[56:57], v[56:57], v[54:55], v[54:55] op_sel_hi:[1,0,0]
    v_pk_fma_f32 v[58:59], v[58:59], v[54:55], v[54:55] op_sel_hi:[1,0,0]
    v_pk_fma_f32 v[60:61], v[60:61], v[54:55], v[54:55] op_sel_hi:[1,0,0]
    v_pk_fma_f32 v[62:63], v[62:63], v[54:55], v[54:55] op_sel_hi:[1,0,0]
    v_rcp_f32 v56, v56
    v_rcp_f32 v57, v57
    v_rcp_f32 v58, v58
    v_rcp_f32 v59, v59
    v_rcp_f32 v60, v60
    v_rcp_f32 v61, v61
    v_rcp_f32 v62, v62
    v_rcp_f32 v63, v63
    v_pk_mul_f32 v[96:97], v[96:97], v[56:57]
    v_pk_mul_f32 v[98:99], v[98:99], v[58:59]
    v_pk_mul_f32 v[100:101], v[100:101], v[60:61]
    v_pk_mul_f32 v[102:103], v[102:103], v[62:63]
    v_cvt_pk_bf16_f32 v160, v96, v97
    v_cvt_pk_bf16_f32 v161, v98, v99
    v_cvt_pk_bf16_f32 v162, v100, v101
    v_cvt_pk_bf16_f32 v163, v102, v103
    s_nop 0
    v_permlane32_swap_b32 v160, v162
    v_permlane32_swap_b32 v161, v163
    ds_write_b128 v7, v[160:163] offset:24576
    v_pk_mul_f32 v[56:57], v[112:113], v[52:53] op_sel_hi:[1,0]
    v_pk_mul_f32 v[58:59], v[114:115], v[52:53] op_sel_hi:[1,0]
    v_pk_mul_f32 v[60:61], v[116:117], v[52:53] op_sel_hi:[1,0]
    v_pk_mul_f32 v[62:63], v[118:119], v[52:53] op_sel_hi:[1,0]
    v_exp_f32 v56, v56
    v_exp_f32 v57, v57
    v_exp_f32 v58, v58
    v_exp_f32 v59, v59
    v_exp_f32 v60, v60
    v_exp_f32 v61, v61
    v_exp_f32 v62, v62
    v_exp_f32 v63, v63
    v_pk_mul_f32 v[112:113], v[112:113], v[120:121]
    v_pk_mul_f32 v[114:115], v[114:115], v[122:123]
    v_pk_mul_f32 v[116:117], v[116:117], v[124:125]
    v_pk_mul_f32 v[118:119], v[118:119], v[126:127]
    v_pk_fma_f32 v[56:57], v[56:57], v[54:55], v[54:55] op_sel_hi:[1,0,0]
    v_pk_fma_f32 v[58:59], v[58:59], v[54:55], v[54:55] op_sel_hi:[1,0,0]
    v_pk_fma_f32 v[60:61], v[60:61], v[54:55], v[54:55] op_sel_hi:[1,0,0]
    v_pk_fma_f32 v[62:63], v[62:63], v[54:55], v[54:55] op_sel_hi:[1,0,0]
    v_rcp_f32 v56, v56
    v_rcp_f32 v57, v57
    v_rcp_f32 v58, v58
    v_rcp_f32 v59, v59
    v_rcp_f32 v60, v60
    v_rcp_f32 v61, v61
    v_rcp_f32 v62, v62
    v_rcp_f32 v63, v63
    v_pk_mul_f32 v[112:113], v[112:113], v[56:57]
    v_pk_mul_f32 v[114:115], v[114:115], v[58:59]
    v_pk_mul_f32 v[116:117], v[116:117], v[60:61]
    v_pk_mul_f32 v[118:119], v[118:119], v[62:63]
    v_cvt_pk_bf16_f32 v164, v112, v113
    v_cvt_pk_bf16_f32 v165, v114, v115
    v_cvt_pk_bf16_f32 v166, v116, v117
    v_cvt_pk_bf16_f32 v167, v118, v119
    s_nop 0
    v_permlane32_swap_b32 v164, v166
    v_permlane32_swap_b32 v165, v167
    ds_write_b128 v10, v[164:167] offset:24576
    s_waitcnt lgkmcnt(0)
    s_barrier
    ds_read_b128 v[168:171], v8 offset:16384
    ds_read_b128 v[172:175], v11 offset:17408
    ds_read_b128 v[176:179], v8 offset:24576
    ds_read_b128 v[180:183], v11 offset:25600
    s_mov_b32 s52, 237568
    s_waitcnt lgkmcnt(3)
    buffer_store_dwordx4 v[168:171], v9, s[40:43], s52 offen sc0 sc1
    s_mov_b32 s52, 252416
    s_waitcnt lgkmcnt(2)
    buffer_store_dwordx4 v[172:175], v9, s[40:43], s52 offen sc0 sc1
    s_mov_b32 s52, 356352
    s_waitcnt lgkmcnt(1)
    buffer_store_dwordx4 v[176:179], v9, s[40:43], s52 offen sc0 sc1
    s_mov_b32 s52, 371200
    s_waitcnt lgkmcnt(0)
    buffer_store_dwordx4 v[180:183], v9, s[40:43], s52 offen sc0 sc1
    s_barrier
    s_add_u32 m0, s56, 16384
    s_mov_b32 s52, 114688
    buffer_load_dwordx4 v184, s[44:47], s52 offen offset:0 lds
    s_mov_b32 s52, 120832
    buffer_load_dwordx4 v184, s[44:47], s52 offen offset:1024 lds
    s_mov_b32 s52, 126976
    buffer_load_dwordx4 v184, s[44:47], s52 offen offset:2048 lds
    s_mov_b32 s52, 133120
    buffer_load_dwordx4 v184, s[44:47], s52 offen offset:3072 lds
    s_add_u32 m0, s56, 20480
    s_mov_b32 s52, 143360
    buffer_load_dwordx4 v184, s[44:47], s52 offen offset:0 lds
    s_mov_b32 s52, 149504
    buffer_load_dwordx4 v184, s[44:47], s52 offen offset:1024 lds
    s_mov_b32 s52, 155648
    buffer_load_dwordx4 v184, s[44:47], s52 offen offset:2048 lds
    s_mov_b32 s52, 161792
    buffer_load_dwordx4 v184, s[44:47], s52 offen offset:3072 lds
    s_waitcnt vmcnt(8)
    s_barrier
    s_cmp_eq_u32 s3, 0
    s_cbranch_scc0 ARR_S3
    s_mov_b64 s[92:93], exec
    s_mov_b64 exec, 1
    s_lshl_b32 s94, s4, 8
    s_add_u32 s94, s94, 0x1e1000
    v_mov_b32 v244, s94
    v_mov_b32 v245, 1
    global_atomic_add v244, v245, s[38:39] sc1
    s_mov_b64 exec, s[92:93]
ARR_S3:
    s_add_u32 m0, s56, 0
    s_mov_b32 s52, 172032
    buffer_load_dwordx4 v184, s[44:47], s52 offen offset:0 lds
    v_lshrrev_b32 v3, 5, v1
    v_bfe_u32 v5, v1, 2, 2
    v_lshl_add_u32 v6, v3, 3, v5
    v_lshlrev_b32 v6, 7, v6
    v_bfe_u32 v7, v1, 4, 1
    s_mov_b32 s52, 178176
    buffer_load_dwordx4 v184, s[44:47], s52 offen offset:1024 lds
    v_lshl_add_u32 v6, v7, 5, v6
    v_and_b32 v7, 3, v1
    v_lshl_add_u32 v6, v7, 3, v6
    v_lshrrev_b32 v5, 1, v5
    s_lshr_b32 s54, s3, 1
    s_mov_b32 s52, 184320
    buffer_load_dwordx4 v184, s[44:47], s52 offen offset:2048 lds
    v_xor_b32 v5, s54, v5
    v_lshl_add_u32 v6, v5, 6, v6
    v_add_u32 v4, s57, v6
    v_xor_b32 v5, 64, v4
    v_add_u32 v6, s56, v6
    s_mov_b32 s52, 190464
    buffer_load_dwordx4 v184, s[44:47], s52 offen offset:3072 lds
    v_xor_b32 v7, 64, v6
    ds_read_b64_tr_b16 a[0:1], v4 offset:0
    ds_read_b64_tr_b16 a[2:3], v4 offset:512
    ds_read_b64_tr_b16 a[4:5], v4 offset:2048
    ds_read_b64_tr_b16 a[6:7], v4 offset:2560
    s_add_u32 m0, s56, 4096
    s_mov_b32 s52, 200704
    buffer_load_dwordx4 v184, s[44:47], s52 offen offset:0 lds
    ds_read_b64_tr_b16 a[8:9], v4 offset:4096
    ds_read_b64_tr_b16 a[10:11], v4 offset:4608
    ds_read_b64_tr_b16 a[12:13], v4 offset:6144
    ds_read_b64_tr_b16 a[14:15], v4 offset:6656
    ds_read_b64_tr_b16 a[112:113], v5 offset:0
    s_mov_b32 s52, 206848
    buffer_load_dwordx4 v184, s[44:47], s52 offen offset:1024 lds
    ds_read_b64_tr_b16 a[114:115], v5 offset:512
    ds_read_b64_tr_b16 a[116:117], v5 offset:2048
    ds_read_b64_tr_b16 a[118:119], v5 offset:2560
    ds_read_b64_tr_b16 a[120:121], v5 offset:4096
    ds_read_b64_tr_b16 a[122:123], v5 offset:4608
    s_mov_b32 s52, 212992
    buffer_load_dwordx4 v184, s[44:47], s52 offen offset:2048 lds
    ds_read_b64_tr_b16 a[124:125], v5 offset:6144
    ds_read_b64_tr_b16 a[126:127], v5 offset:6656
    ds_read_b64_tr_b16 a[16:17], v4 offset:8192
    ds_read_b64_tr_b16 a[18:19], v4 offset:8704
    s_mov_b32 s52, 219136
    buffer_load_dwordx4 v184, s[44:47], s52 offen offset:3072 lds
    ds_read_b64_tr_b16 a[20:21], v4 offset:10240
    ds_read_b64_tr_b16 a[22:23], v4 offset:10752
    ds_read_b64_tr_b16 a[24:25], v4 offset:12288
    ds_read_b64_tr_b16 a[26:27], v4 offset:12800
    s_add_u32 m0, s56, 8192
    s_mov_b32 s52, 229376
    buffer_load_dwordx4 v184, s[44:47], s52 offen offset:0 lds
    ds_read_b64_tr_b16 a[28:29], v4 offset:14336
    ds_read_b64_tr_b16 a[30:31], v4 offset:14848
    ds_read_b64_tr_b16 a[128:129], v5 offset:8192
    ds_read_b64_tr_b16 a[130:131], v5 offset:8704
    s_mov_b32 s52, 235520
    buffer_load_dwordx4 v184, s[44:47], s52 offen offset:1024 lds
    ds_read_b64_tr_b16 a[132:133], v5 offset:10240
    ds_read_b64_tr_b16 a[134:135], v5 offset:10752
    ds_read_b64_tr_b16 a[136:137], v5 offset:12288
    ds_read_b64_tr_b16 a[138:139], v5 offset:12800
    s_mov_b32 s52, 241664
    buffer_load_dwordx4 v184, s[44:47], s52 offen offset:2048 lds
    ds_read_b64_tr_b16 a[140:141], v5 offset:14336
    ds_read_b64_tr_b16 a[142:143], v5 offset:14848
    v_lshrrev_b32 v3, 3, v1
    v_and_b32 v12, 7, v1
    s_mov_b32 s52, 247808
    buffer_load_dwordx4 v184, s[44:47], s52 offen offset:3072 lds
    v_lshrrev_b32 v13, 4, v1
    v_xor_b32 v8, v13, v12
    v_xor_b32 v9, 4, v8
    v_mul_u32_u24 v10, 3712, v3
    s_add_u32 m0, s56, 12288
    s_mov_b32 s52, 258048
    buffer_load_dwordx4 v184, s[44:47], s52 offen offset:0 lds
    s_mul_i32 s54, s6, 237568
    s_mul_i32 s55, s3, 896
    s_add_u32 s54, s54, s55
    s_add_u32 s54, s54, 0x400000
    s_mov_b32 s52, 264192
    buffer_load_dwordx4 v184, s[44:47], s52 offen offset:1024 lds
    v_add_u32 v10, s54, v10
    v_lshl_add_u32 v8, v8, 4, v10
    v_lshl_add_u32 v9, v9, 4, v10
    s_lshl_b32 s54, s3, 4
    s_mov_b32 s52, 270336
    buffer_load_dwordx4 v184, s[44:47], s52 offen offset:2048 lds
    v_add_u32 v11, s54, v3
    s_lshl_b32 s54, s7, 6
    v_add_u32 v11, s54, v11
    v_mul_u32_u24 v11, 4224, v11
    s_mov_b32 s52, 276480
    buffer_load_dwordx4 v184, s[44:47], s52 offen offset:3072 lds
    v_lshl_add_u32 v11, v12, 4, v11
    s_lshl_b32 s54, s6, 7
    s_add_u32 s54, s54, 0x200000
    v_add_u32 v11, s54, v11
    s_waitcnt lgkmcnt(0)
    s_waitcnt vmcnt(16)
    ds_read_b64_tr_b16 a[32:33], v6 offset:16384
    ds_read_b64_tr_b16 a[34:35], v6 offset:16896
    ds_read_b64_tr_b16 a[36:37], v6 offset:18432
    ds_read_b64_tr_b16 a[38:39], v6 offset:18944
    ds_read_b64_tr_b16 a[40:41], v6 offset:20480
    ds_read_b64_tr_b16 a[42:43], v6 offset:20992
    ds_read_b64_tr_b16 a[44:45], v6 offset:22528
    ds_read_b64_tr_b16 a[46:47], v6 offset:23040
    ds_read_b64_tr_b16 a[144:145], v7 offset:16384
    ds_read_b64_tr_b16 a[146:147], v7 offset:16896
    ds_read_b64_tr_b16 a[148:149], v7 offset:18432
    ds_read_b64_tr_b16 a[150:151], v7 offset:18944
    ds_read_b64_tr_b16 a[152:153], v7 offset:20480
    ds_read_b64_tr_b16 a[154:155], v7 offset:20992
    ds_read_b64_tr_b16 a[156:157], v7 offset:22528
    ds_read_b64_tr_b16 a[158:159], v7 offset:23040
    s_waitcnt lgkmcnt(0)
    s_add_u32 m0, s56, 16384
    s_mov_b32 s52, 286720
    buffer_load_dwordx4 v184, s[44:47], s52 offen offset:0 lds
    s_mov_b32 s52, 292864
    buffer_load_dwordx4 v184, s[44:47], s52 offen offset:1024 lds
    s_mov_b32 s52, 299008
    buffer_load_dwordx4 v184, s[44:47], s52 offen offset:2048 lds
    s_mov_b32 s52, 305152
    buffer_load_dwordx4 v184, s[44:47], s52 offen offset:3072 lds
    s_add_u32 m0, s56, 20480
    s_mov_b32 s52, 315392
    buffer_load_dwordx4 v184, s[44:47], s52 offen offset:0 lds
    s_mov_b32 s52, 321536
    buffer_load_dwordx4 v184, s[44:47], s52 offen offset:1024 lds
    s_mov_b32 s52, 327680
    buffer_load_dwordx4 v184, s[44:47], s52 offen offset:2048 lds
    s_mov_b32 s52, 333824
    buffer_load_dwordx4 v184, s[44:47], s52 offen offset:3072 lds
    s_waitcnt vmcnt(16)
    ds_read_b64_tr_b16 a[48:49], v6 offset:0
    ds_read_b64_tr_b16 a[50:51], v6 offset:512
    ds_read_b64_tr_b16 a[52:53], v6 offset:2048
    ds_read_b64_tr_b16 a[54:55], v6 offset:2560
    ds_read_b64_tr_b16 a[56:57], v6 offset:4096
    ds_read_b64_tr_b16 a[58:59], v6 offset:4608
    ds_read_b64_tr_b16 a[60:61], v6 offset:6144
    ds_read_b64_tr_b16 a[62:63], v6 offset:6656
    ds_read_b64_tr_b16 a[160:161], v7 offset:0
    ds_read_b64_tr_b16 a[162:163], v7 offset:512
    ds_read_b64_tr_b16 a[164:165], v7 offset:2048
    ds_read_b64_tr_b16 a[166:167], v7 offset:2560
    ds_read_b64_tr_b16 a[168:169], v7 offset:4096
    ds_read_b64_tr_b16 a[170:171], v7 offset:4608
    ds_read_b64_tr_b16 a[172:173], v7 offset:6144
    ds_read_b64_tr_b16 a[174:175], v7 offset:6656
    s_waitcnt lgkmcnt(0)
    s_cmp_eq_u32 s3, 0
    s_cbranch_scc0 PS_3857
    s_mov_b64 s[92:93], exec
    s_mov_b64 exec, 0x1
    s_lshl_b32 s94, s4, 8
    s_add_u32 s94, s94, 0x1e1000
    v_mov_b32 v244, s94
    global_load_dword v245, v244, s[38:39] sc0 sc1
    s_mov_b64 exec, s[92:93]
PS_3857:
    s_add_u32 m0, s56, 0
    s_mov_b32 s52, 344064
    buffer_load_dwordx4 v184, s[44:47], s52 offen offset:0 lds
    s_mov_b32 s52, 350208
    buffer_load_dwordx4 v184, s[44:47], s52 offen offset:1024 lds
    s_mov_b32 s52, 356352
    buffer_load_dwordx4 v184, s[44:47], s52 offen offset:2048 lds
    s_mov_b32 s52, 362496
    buffer_load_dwordx4 v184, s[44:47], s52 offen offset:3072 lds
    s_add_u32 m0, s56, 4096
    s_mov_b32 s52, 372736
    buffer_load_dwordx4 v184, s[44:47], s52 offen offset:0 lds
    s_mov_b32 s52, 378880
    buffer_load_dwordx4 v184, s[44:47], s52 offen offset:1024 lds
    s_mov_b32 s52, 385024
    buffer_load_dwordx4 v184, s[44:47], s52 offen offset:2048 lds
    s_mov_b32 s52, 391168
    buffer_load_dwordx4 v184, s[44:47], s52 offen offset:3072 lds
    s_waitcnt vmcnt(16)
    ds_read_b64_tr_b16 a[64:65], v6 offset:8192
    ds_read_b64_tr_b16 a[66:67], v6 offset:8704
    ds_read_b64_tr_b16 a[68:69], v6 offset:10240
    ds_read_b64_tr_b16 a[70:71], v6 offset:10752
    ds_read_b64_tr_b16 a[72:73], v6 offset:12288
    ds_read_b64_tr_b16 a[74:75], v6 offset:12800
    ds_read_b64_tr_b16 a[76:77], v6 offset:14336
    ds_read_b64_tr_b16 a[78:79], v6 offset:14848
    ds_read_b64_tr_b16 a[176:177], v7 offset:8192
    ds_read_b64_tr_b16 a[178:179], v7 offset:8704
    ds_read_b64_tr_b16 a[180:181], v7 offset:10240
    ds_read_b64_tr_b16 a[182:183], v7 offset:10752
    ds_read_b64_tr_b16 a[184:185], v7 offset:12288
    ds_read_b64_tr_b16 a[186:187], v7 offset:12800
    ds_read_b64_tr_b16 a[188:189], v7 offset:14336
    ds_read_b64_tr_b16 a[190:191], v7 offset:14848
    s_waitcnt lgkmcnt(0)
    s_cmp_eq_u32 s3, 0
    s_cbranch_scc0 POLL_S3_D
    s_mov_b64 s[92:93], exec
    s_mov_b64 exec, 0x1
    s_mov_b32 s94, 0
    s_waitcnt vmcnt(8)
    s_branch POLL_S3_C
POLL_S3_L:
    global_load_dword v245, v244, s[38:39] sc0 sc1
    s_waitcnt vmcnt(0)
POLL_S3_C:
    s_add_u32 s94, s94, 1
    v_cmp_gt_u32 vcc, 14, v245
    s_cmp_gt_u32 s94, 0x40000
    s_cbranch_scc1 POLL_S3_X
    s_and_b64 vcc, vcc, exec
    s_cbranch_vccz POLL_S3_X
    s_branch POLL_S3_L
POLL_S3_X:
    s_mov_b64 exec, s[92:93]
POLL_S3_D:
    s_barrier
    s_add_u32 m0, s56, 8192
    s_mov_b32 s89, 0
    buffer_load_dwordx4 v8, s[40:43], s89 offen offset:0 sc1 lds
    s_mov_b32 s48, s34
    s_and_b32 s49, s35, 0xffff
    s_mov_b32 s50, 0x1c0000
    s_mov_b32 s51, 0x20000
    v_and_b32 v3, 31, v1
    s_mov_b32 s89, 28672
    buffer_load_dwordx4 v9, s[40:43], s89 offen offset:1024 sc1 lds
    v_bfe_u32 v4, v1, 1, 3
    v_lshrrev_b32 v5, 5, v1
    v_xor_b32 v4, v4, v5
    v_lshlrev_b32 v4, 4, v4
    v_lshl_add_u32 v4, v3, 7, v4
    s_mov_b32 s89, 57344
    buffer_load_dwordx4 v8, s[40:43], s89 offen offset:2048 sc1 lds
    s_and_b32 s52, s3, 1
    s_lshl_b32 s52, s52, 12
    v_add_u32 v4, s52, v4
    v_add_u32 v5, s56, v4
    v_xor_b32 v14, 0, v5
    s_mov_b32 s89, 86016
    buffer_load_dwordx4 v9, s[40:43], s89 offen offset:3072 sc1 lds
    v_xor_b32 v18, 4096, v14
    v_xor_b32 v15, 32, v5
    v_xor_b32 v19, 4096, v15
    v_xor_b32 v16, 64, v5
    v_xor_b32 v20, 4096, v16
    s_add_u32 m0, s56, 12288
    s_mov_b32 s89, 118784
    buffer_load_dwordx4 v8, s[40:43], s89 offen offset:0 sc1 lds
    v_xor_b32 v17, 96, v5
    v_xor_b32 v21, 4096, v17
    v_add_u32 v5, s57, v4
    v_xor_b32 v48, 0, v5
    v_xor_b32 v52, 4096, v48
    s_mov_b32 s89, 147456
    buffer_load_dwordx4 v9, s[40:43], s89 offen offset:1024 sc1 lds
    v_xor_b32 v49, 32, v5
    v_xor_b32 v53, 4096, v49
    v_xor_b32 v50, 64, v5
    v_xor_b32 v54, 4096, v50
    v_xor_b32 v51, 96, v5
    s_mov_b32 s89, 176128
    buffer_load_dwordx4 v8, s[40:43], s89 offen offset:2048 sc1 lds
    v_xor_b32 v55, 4096, v51
    v_lshlrev_b32 v44, 4, v1
    v_add_u32 v45, s56, v44
    s_xor_b32 s52, s3, 1
    s_mul_i32 s52, s52, 24576
    s_mov_b32 s89, 204800
    buffer_load_dwordx4 v9, s[40:43], s89 offen offset:3072 sc1 lds
    v_add_u32 v57, s52, v44
    s_xor_b32 s52, s3, 2
    s_mul_i32 s52, s52, 24576
    v_add_u32 v58, s52, v44
    s_add_u32 m0, s57, 0
    s_mov_b32 s89, 128
    buffer_load_dwordx4 v8, s[40:43], s89 offen offset:0 sc1 lds
    s_xor_b32 s52, s3, 3
    s_mul_i32 s52, s52, 24576
    v_add_u32 v59, s52, v44
    v_lshrrev_b32 v40, 5, v1
    s_mov_b32 s89, 28800
    buffer_load_dwordx4 v9, s[40:43], s89 offen offset:1024 sc1 lds
    v_lshlrev_b32 v40, 2, v40
    v_bfe_u32 v41, v1, 2, 2
    v_add_u32 v40, v40, v41
    v_lshlrev_b32 v40, 7, v40
    s_mov_b32 s89, 57472
    buffer_load_dwordx4 v8, s[40:43], s89 offen offset:2048 sc1 lds
    v_bfe_u32 v41, v1, 4, 1
    v_lshl_add_u32 v40, v41, 5, v40
    v_and_b32 v41, 3, v1
    v_lshl_add_u32 v40, v41, 3, v40
    s_mov_b32 s89, 86144
    buffer_load_dwordx4 v9, s[40:43], s89 offen offset:3072 sc1 lds
    s_lshr_b32 s52, s3, 1
    s_lshl_b32 s53, s52, 15
    s_add_u32 s53, s53, 106496
    s_and_b32 s52, s3, 1
    s_add_u32 m0, s57, 4096
    s_mov_b32 s89, 118912
    buffer_load_dwordx4 v8, s[40:43], s89 offen offset:0 sc1 lds
    s_lshl_b32 s54, s52, 6
    s_add_u32 s53, s53, s54
    v_add_u32 v40, s53, v40
    v_and_b32 v42, 31, v1
    s_mov_b32 s89, 147584
    buffer_load_dwordx4 v9, s[40:43], s89 offen offset:1024 sc1 lds
    s_lshl_b32 s52, s52, 5
    s_lshl_b32 s53, s6, 6
    s_add_u32 s52, s52, s53
    v_add_u32 v42, s52, v42
    s_mov_b32 s89, 176256
    buffer_load_dwordx4 v8, s[40:43], s89 offen offset:2048 sc1 lds
    v_mul_u32_u24 v42, 896, v42
    v_lshrrev_b32 v43, 5, v1
    v_lshl_add_u32 v42, v43, 4, v42
    s_lshr_b32 s52, s3, 1
    s_mov_b32 s89, 204928
    buffer_load_dwordx4 v9, s[40:43], s89 offen offset:3072 sc1 lds
    s_lshl_b32 s52, s52, 6
    s_lshl_b32 s53, s7, 7
    s_add_u32 s52, s52, s53
    v_add_u32 v42, s52, v42
    s_waitcnt vmcnt(8)
    ds_read_b128 v[128:131], v14 offset:8192
    ds_read_b128 v[132:135], v18 offset:8192
    ds_read_b128 v[136:139], v15 offset:8192
    ds_read_b128 v[140:143], v19 offset:8192
    ds_read_b128 v[144:147], v16 offset:8192
    ds_read_b128 v[148:151], v20 offset:8192
    ds_read_b128 v[152:155], v17 offset:8192
    ds_read_b128 v[156:159], v21 offset:8192
    s_waitcnt lgkmcnt(0)
    v_mfma_f32_32x32x16_bf16 v[64:79], a[0:3], v[128:131], 0
    ds_read_b64_tr_b16 a[80:81], v6 offset:16384
    ds_read_b64_tr_b16 a[82:83], v6 offset:16896
    v_mfma_f32_32x32x16_bf16 v[80:95], a[0:3], v[132:135], 0
    ds_read_b64_tr_b16 a[84:85], v6 offset:18432
    ds_read_b64_tr_b16 a[86:87], v6 offset:18944
    s_add_u32 m0, s57, 8192
    s_mov_b32 s52, 256
    buffer_load_dwordx4 v8, s[40:43], s52 offen offset:0 sc1 lds
    v_mfma_f32_32x32x16_bf16 v[96:111], a[112:115], v[128:131], 0
    ds_read_b64_tr_b16 a[88:89], v6 offset:20480
    ds_read_b64_tr_b16 a[90:91], v6 offset:20992
    v_mfma_f32_32x32x16_bf16 v[112:127], a[112:115], v[132:135], 0
    ds_read_b64_tr_b16 a[92:93], v6 offset:22528
    ds_read_b64_tr_b16 a[94:95], v6 offset:23040
    s_mov_b32 s52, 28928
    buffer_load_dwordx4 v9, s[40:43], s52 offen offset:1024 sc1 lds
    v_mfma_f32_32x32x16_bf16 v[64:79], a[4:7], v[136:139], v[64:79]
    ds_read_b64_tr_b16 a[192:193], v7 offset:16384
    ds_read_b64_tr_b16 a[194:195], v7 offset:16896
    v_mfma_f32_32x32x16_bf16 v[80:95], a[4:7], v[140:143], v[80:95]
    ds_read_b64_tr_b16 a[196:197], v7 offset:18432
    ds_read_b64_tr_b16 a[198:199], v7 offset:18944
    s_mov_b32 s52, 57600
    buffer_load_dwordx4 v8, s[40:43], s52 offen offset:2048 sc1 lds
    v_mfma_f32_32x32x16_bf16 v[96:111], a[116:119], v[136:139], v[96:111]
    ds_read_b64_tr_b16 a[200:201], v7 offset:20480
    ds_read_b64_tr_b16 a[202:203], v7 offset:20992
    s_mov_b32 s52, 86272
    buffer_load_dwordx4 v9, s[40:43], s52 offen offset:3072 sc1 lds
    v_mfma_f32_32x32x16_bf16 v[112:127], a[116:119], v[140:143], v[112:127]
    ds_read_b64_tr_b16 a[204:205], v7 offset:22528
    ds_read_b64_tr_b16 a[206:207], v7 offset:23040
    v_mfma_f32_32x32x16_bf16 v[64:79], a[8:11], v[144:147], v[64:79]
    s_add_u32 m0, s57, 12288
    s_mov_b32 s52, 119040
    buffer_load_dwordx4 v8, s[40:43], s52 offen offset:0 sc1 lds
    v_mfma_f32_32x32x16_bf16 v[80:95], a[8:11], v[148:151], v[80:95]
    s_mov_b32 s52, 147712
    buffer_load_dwordx4 v9, s[40:43], s52 offen offset:1024 sc1 lds
    v_mfma_f32_32x32x16_bf16 v[96:111], a[120:123], v[144:147], v[96:111]
    s_mov_b32 s52, 176384
    buffer_load_dwordx4 v8, s[40:43], s52 offen offset:2048 sc1 lds
    v_mfma_f32_32x32x16_bf16 v[112:127], a[120:123], v[148:151], v[112:127]
    s_mov_b32 s52, 205056
    buffer_load_dwordx4 v9, s[40:43], s52 offen offset:3072 sc1 lds
    s_waitcnt vmcnt(8)
    v_mfma_f32_32x32x16_bf16 v[64:79], a[12:15], v[152:155], v[64:79]
    ds_read_b128 v[160:163], v48 offset:0
    ds_read_b128 v[164:167], v52 offset:0
    ds_read_b128 v[168:171], v49 offset:0
    ds_read_b128 v[172:175], v53 offset:0
    v_mfma_f32_32x32x16_bf16 v[80:95], a[12:15], v[156:159], v[80:95]
    ds_read_b128 v[176:179], v50 offset:0
    ds_read_b128 v[180:183], v54 offset:0
    ds_read_b128 v[184:187], v51 offset:0
    ds_read_b128 v[188:191], v55 offset:0
    v_mfma_f32_32x32x16_bf16 v[96:111], a[124:127], v[152:155], v[96:111]
    v_mfma_f32_32x32x16_bf16 v[112:127], a[124:127], v[156:159], v[112:127]
    s_waitcnt lgkmcnt(8)
    s_waitcnt lgkmcnt(0)
    v_mfma_f32_32x32x16_bf16 v[64:79], a[16:19], v[160:163], v[64:79]
    ds_read_b64_tr_b16 a[96:97], v6 offset:0
    ds_read_b64_tr_b16 a[98:99], v6 offset:512
    v_mfma_f32_32x32x16_bf16 v[80:95], a[16:19], v[164:167], v[80:95]
    ds_read_b64_tr_b16 a[100:101], v6 offset:2048
    ds_read_b64_tr_b16 a[102:103], v6 offset:2560
    s_add_u32 m0, s56, 16384
    s_mov_b32 s52, 384
    buffer_load_dwordx4 v8, s[40:43], s52 offen offset:0 sc1 lds
    v_mfma_f32_32x32x16_bf16 v[96:111], a[128:131], v[160:163], v[96:111]
    ds_read_b64_tr_b16 a[104:105], v6 offset:4096
    ds_read_b64_tr_b16 a[106:107], v6 offset:4608
    v_mfma_f32_32x32x16_bf16 v[112:127], a[128:131], v[164:167], v[112:127]
    ds_read_b64_tr_b16 a[108:109], v6 offset:6144
    ds_read_b64_tr_b16 a[110:111], v6 offset:6656
    s_mov_b32 s52, 29056
    buffer_load_dwordx4 v9, s[40:43], s52 offen offset:1024 sc1 lds
    v_mfma_f32_32x32x16_bf16 v[64:79], a[20:23], v[168:171], v[64:79]
    ds_read_b64_tr_b16 a[208:209], v7 offset:0
    ds_read_b64_tr_b16 a[210:211], v7 offset:512
    v_mfma_f32_32x32x16_bf16 v[80:95], a[20:23], v[172:175], v[80:95]
    ds_read_b64_tr_b16 a[212:213], v7 offset:2048
    ds_read_b64_tr_b16 a[214:215], v7 offset:2560
    s_mov_b32 s52, 57728
    buffer_load_dwordx4 v8, s[40:43], s52 offen offset:2048 sc1 lds
    v_mfma_f32_32x32x16_bf16 v[96:111], a[132:135], v[168:171], v[96:111]
    ds_read_b64_tr_b16 a[216:217], v7 offset:4096
    ds_read_b64_tr_b16 a[218:219], v7 offset:4608
    s_mov_b32 s52, 86400
    buffer_load_dwordx4 v9, s[40:43], s52 offen offset:3072 sc1 lds
    v_mfma_f32_32x32x16_bf16 v[112:127], a[132:135], v[172:175], v[112:127]
    ds_read_b64_tr_b16 a[220:221], v7 offset:6144
    ds_read_b64_tr_b16 a[222:223], v7 offset:6656
    v_mfma_f32_32x32x16_bf16 v[64:79], a[24:27], v[176:179], v[64:79]
    s_add_u32 m0, s56, 20480
    s_mov_b32 s52, 119168
    buffer_load_dwordx4 v8, s[40:43], s52 offen offset:0 sc1 lds
    v_mfma_f32_32x32x16_bf16 v[80:95], a[24:27], v[180:183], v[80:95]
    s_mov_b32 s52, 147840
    buffer_load_dwordx4 v9, s[40:43], s52 offen offset:1024 sc1 lds
    v_mfma_f32_32x32x16_bf16 v[96:111], a[136:139], v[176:179], v[96:111]
    s_mov_b32 s52, 176512
    buffer_load_dwordx4 v8, s[40:43], s52 offen offset:2048 sc1 lds
    v_mfma_f32_32x32x16_bf16 v[112:127], a[136:139], v[180:183], v[112:127]
    s_mov_b32 s52, 205184
    buffer_load_dwordx4 v9, s[40:43], s52 offen offset:3072 sc1 lds
    s_waitcnt vmcnt(8)
    v_mfma_f32_32x32x16_bf16 v[64:79], a[28:31], v[184:187], v[64:79]
    ds_read_b128 v[128:131], v48 offset:8192
    ds_read_b128 v[132:135], v52 offset:8192
    ds_read_b128 v[136:139], v49 offset:8192
    ds_read_b128 v[140:143], v53 offset:8192
    v_mfma_f32_32x32x16_bf16 v[80:95], a[28:31], v[188:191], v[80:95]
    ds_read_b128 v[144:147], v50 offset:8192
    ds_read_b128 v[148:151], v54 offset:8192
    ds_read_b128 v[152:155], v51 offset:8192
    ds_read_b128 v[156:159], v55 offset:8192
    v_mfma_f32_32x32x16_bf16 v[96:111], a[140:143], v[184:187], v[96:111]
    v_mfma_f32_32x32x16_bf16 v[112:127], a[140:143], v[188:191], v[112:127]
    s_waitcnt lgkmcnt(8)
    s_waitcnt lgkmcnt(0)
    v_mfma_f32_32x32x16_bf16 v[64:79], a[32:35], v[128:131], v[64:79]
    v_mfma_f32_32x32x16_bf16 v[80:95], a[32:35], v[132:135], v[80:95]
    s_add_u32 m0, s56, 0
    s_mov_b32 s52, 512
    buffer_load_dwordx4 v8, s[40:43], s52 offen offset:0 sc1 lds
    v_mfma_f32_32x32x16_bf16 v[96:111], a[144:147], v[128:131], v[96:111]
    v_mfma_f32_32x32x16_bf16 v[112:127], a[144:147], v[132:135], v[112:127]
    s_mov_b32 s52, 29184
    buffer_load_dwordx4 v9, s[40:43], s52 offen offset:1024 sc1 lds
    v_mfma_f32_32x32x16_bf16 v[64:79], a[36:39], v[136:139], v[64:79]
    s_mov_b32 s52, 57856
    buffer_load_dwordx4 v8, s[40:43], s52 offen offset:2048 sc1 lds
    v_mfma_f32_32x32x16_bf16 v[80:95], a[36:39], v[140:143], v[80:95]
    s_mov_b32 s52, 86528
    buffer_load_dwordx4 v9, s[40:43], s52 offen offset:3072 sc1 lds
    v_mfma_f32_32x32x16_bf16 v[96:111], a[148:151], v[136:139], v[96:111]
    v_mfma_f32_32x32x16_bf16 v[112:127], a[148:151], v[140:143], v[112:127]
    s_add_u32 m0, s56, 4096
    s_mov_b32 s52, 119296
    buffer_load_dwordx4 v8, s[40:43], s52 offen offset:0 sc1 lds
    v_mfma_f32_32x32x16_bf16 v[64:79], a[40:43], v[144:147], v[64:79]
    v_mfma_f32_32x32x16_bf16 v[80:95], a[40:43], v[148:151], v[80:95]
    s_mov_b32 s52, 147968
    buffer_load_dwordx4 v9, s[40:43], s52 offen offset:1024 sc1 lds
    v_mfma_f32_32x32x16_bf16 v[96:111], a[152:155], v[144:147], v[96:111]
    s_mov_b32 s52, 176640
    buffer_load_dwordx4 v8, s[40:43], s52 offen offset:2048 sc1 lds
    v_mfma_f32_32x32x16_bf16 v[112:127], a[152:155], v[148:151], v[112:127]
    s_mov_b32 s52, 205312
    buffer_load_dwordx4 v9, s[40:43], s52 offen offset:3072 sc1 lds
    s_waitcnt vmcnt(8)
    v_mfma_f32_32x32x16_bf16 v[64:79], a[44:47], v[152:155], v[64:79]
    ds_read_b128 v[160:163], v14 offset:16384
    ds_read_b128 v[164:167], v18 offset:16384
    ds_read_b128 v[168:171], v15 offset:16384
    ds_read_b128 v[172:175], v19 offset:16384
    v_mfma_f32_32x32x16_bf16 v[80:95], a[44:47], v[156:159], v[80:95]
    ds_read_b128 v[176:179], v16 offset:16384
    ds_read_b128 v[180:183], v20 offset:16384
    ds_read_b128 v[184:187], v17 offset:16384
    ds_read_b128 v[188:191], v21 offset:16384
    v_mfma_f32_32x32x16_bf16 v[96:111], a[156:159], v[152:155], v[96:111]
    v_mfma_f32_32x32x16_bf16 v[112:127], a[156:159], v[156:159], v[112:127]
    s_waitcnt lgkmcnt(0)
    v_mfma_f32_32x32x16_bf16 v[64:79], a[48:51], v[160:163], v[64:79]
    v_mfma_f32_32x32x16_bf16 v[80:95], a[48:51], v[164:167], v[80:95]
    s_add_u32 m0, s56, 8192
    s_mov_b32 s52, 640
    buffer_load_dwordx4 v8, s[40:43], s52 offen offset:0 sc1 lds
    v_mfma_f32_32x32x16_bf16 v[96:111], a[160:163], v[160:163], v[96:111]
    s_mov_b32 s52, 29312
    buffer_load_dwordx4 v9, s[40:43], s52 offen offset:1024 sc1 lds
    v_mfma_f32_32x32x16_bf16 v[112:127], a[160:163], v[164:167], v[112:127]
    s_mov_b32 s52, 57984
    buffer_load_dwordx4 v8, s[40:43], s52 offen offset:2048 sc1 lds
    v_mfma_f32_32x32x16_bf16 v[64:79], a[52:55], v[168:171], v[64:79]
    s_mov_b32 s52, 86656
    buffer_load_dwordx4 v9, s[40:43], s52 offen offset:3072 sc1 lds
    v_mfma_f32_32x32x16_bf16 v[80:95], a[52:55], v[172:175], v[80:95]
    v_mfma_f32_32x32x16_bf16 v[96:111], a[164:167], v[168:171], v[96:111]
    s_add_u32 m0, s56, 12288
    s_mov_b32 s52, 119424
    buffer_load_dwordx4 v8, s[40:43], s52 offen offset:0 sc1 lds
    v_mfma_f32_32x32x16_bf16 v[112:127], a[164:167], v[172:175], v[112:127]
    s_mov_b32 s52, 148096
    buffer_load_dwordx4 v9, s[40:43], s52 offen offset:1024 sc1 lds
    v_mfma_f32_32x32x16_bf16 v[64:79], a[56:59], v[176:179], v[64:79]
    s_mov_b32 s52, 176768
    buffer_load_dwordx4 v8, s[40:43], s52 offen offset:2048 sc1 lds
    v_mfma_f32_32x32x16_bf16 v[80:95], a[56:59], v[180:183], v[80:95]
    s_mov_b32 s52, 205440
    buffer_load_dwordx4 v9, s[40:43], s52 offen offset:3072 sc1 lds
    v_mfma_f32_32x32x16_bf16 v[96:111], a[168:171], v[176:179], v[96:111]
    s_add_u32 m0, s57, 8192
    s_mov_b32 s52, 0
    buffer_load_dwordx4 v11, s[40:43], s52 offen sc1 lds
    v_mfma_f32_32x32x16_bf16 v[112:127], a[168:171], v[180:183], v[112:127]
    s_mov_b32 s52, 32768
    buffer_load_dwordx4 v11, s[40:43], s52 offen offset:1024 sc1 lds
    s_waitcnt vmcnt(10)
    v_mfma_f32_32x32x16_bf16 v[64:79], a[60:63], v[184:187], v[64:79]
    ds_read_b128 v[128:131], v14 offset:0
    ds_read_b128 v[132:135], v18 offset:0
    ds_read_b128 v[136:139], v15 offset:0
    ds_read_b128 v[140:143], v19 offset:0
    v_mfma_f32_32x32x16_bf16 v[80:95], a[60:63], v[188:191], v[80:95]
    ds_read_b128 v[144:147], v16 offset:0
    ds_read_b128 v[148:151], v20 offset:0
    ds_read_b128 v[152:155], v17 offset:0
    ds_read_b128 v[156:159], v21 offset:0
    v_mfma_f32_32x32x16_bf16 v[96:111], a[172:175], v[184:187], v[96:111]
    v_mfma_f32_32x32x16_bf16 v[112:127], a[172:175], v[188:191], v[112:127]
    s_waitcnt lgkmcnt(0)
    v_mfma_f32_32x32x16_bf16 v[64:79], a[64:67], v[128:131], v[64:79]
    v_mfma_f32_32x32x16_bf16 v[80:95], a[64:67], v[132:135], v[80:95]
    s_add_u32 m0, s57, 0
    s_mov_b32 s52, 768
    buffer_load_dwordx4 v8, s[40:43], s52 offen offset:0 sc1 lds
    v_mfma_f32_32x32x16_bf16 v[96:111], a[176:179], v[128:131], v[96:111]
    v_mfma_f32_32x32x16_bf16 v[112:127], a[176:179], v[132:135], v[112:127]
    s_mov_b32 s52, 29440
    buffer_load_dwordx4 v9, s[40:43], s52 offen offset:1024 sc1 lds
    v_mfma_f32_32x32x16_bf16 v[64:79], a[68:71], v[136:139], v[64:79]
    s_mov_b32 s52, 58112
    buffer_load_dwordx4 v8, s[40:43], s52 offen offset:2048 sc1 lds
    v_mfma_f32_32x32x16_bf16 v[80:95], a[68:71], v[140:143], v[80:95]
    s_mov_b32 s52, 86784
    buffer_load_dwordx4 v9, s[40:43], s52 offen offset:3072 sc1 lds
    v_mfma_f32_32x32x16_bf16 v[96:111], a[180:183], v[136:139], v[96:111]
    v_mfma_f32_32x32x16_bf16 v[112:127], a[180:183], v[140:143], v[112:127]
    s_add_u32 m0, s57, 4096
    s_mov_b32 s52, 119552
    buffer_load_dwordx4 v8, s[40:43], s52 offen offset:0 sc1 lds
    v_mfma_f32_32x32x16_bf16 v[64:79], a[72:75], v[144:147], v[64:79]
    v_mfma_f32_32x32x16_bf16 v[80:95], a[72:75], v[148:151], v[80:95]
    s_mov_b32 s52, 148224
    buffer_load_dwordx4 v9, s[40:43], s52 offen offset:1024 sc1 lds
    v_mfma_f32_32x32x16_bf16 v[96:111], a[184:187], v[144:147], v[96:111]
    s_mov_b32 s52, 176896
    buffer_load_dwordx4 v8, s[40:43], s52 offen offset:2048 sc1 lds
    v_mfma_f32_32x32x16_bf16 v[112:127], a[184:187], v[148:151], v[112:127]
    s_mov_b32 s52, 205568
    buffer_load_dwordx4 v9, s[40:43], s52 offen offset:3072 sc1 lds
    s_waitcnt vmcnt(10)
    v_mfma_f32_32x32x16_bf16 v[64:79], a[76:79], v[152:155], v[64:79]
    ds_read_b128 v[160:163], v14 offset:8192
    ds_read_b128 v[164:167], v18 offset:8192
    ds_read_b128 v[168:171], v15 offset:8192
    ds_read_b128 v[172:175], v19 offset:8192
    v_mfma_f32_32x32x16_bf16 v[80:95], a[76:79], v[156:159], v[80:95]
    ds_read_b128 v[176:179], v16 offset:8192
    ds_read_b128 v[180:183], v20 offset:8192
    ds_read_b128 v[184:187], v17 offset:8192
    ds_read_b128 v[188:191], v21 offset:8192
    v_mfma_f32_32x32x16_bf16 v[96:111], a[188:191], v[152:155], v[96:111]
    v_mfma_f32_32x32x16_bf16 v[112:127], a[188:191], v[156:159], v[112:127]
    s_waitcnt lgkmcnt(0)
    v_mfma_f32_32x32x16_bf16 v[64:79], a[80:83], v[160:163], v[64:79]
    v_mfma_f32_32x32x16_bf16 v[80:95], a[80:83], v[164:167], v[80:95]
    v_mfma_f32_32x32x16_bf16 v[96:111], a[192:195], v[160:163], v[96:111]
    v_mfma_f32_32x32x16_bf16 v[112:127], a[192:195], v[164:167], v[112:127]
    v_mfma_f32_32x32x16_bf16 v[64:79], a[84:87], v[168:171], v[64:79]
    v_mfma_f32_32x32x16_bf16 v[80:95], a[84:87], v[172:175], v[80:95]
    v_mfma_f32_32x32x16_bf16 v[96:111], a[196:199], v[168:171], v[96:111]
    v_mfma_f32_32x32x16_bf16 v[112:127], a[196:199], v[172:175], v[112:127]
    v_mfma_f32_32x32x16_bf16 v[64:79], a[88:91], v[176:179], v[64:79]
    v_mfma_f32_32x32x16_bf16 v[80:95], a[88:91], v[180:183], v[80:95]
    v_mfma_f32_32x32x16_bf16 v[96:111], a[200:203], v[176:179], v[96:111]
    v_mfma_f32_32x32x16_bf16 v[112:127], a[200:203], v[180:183], v[112:127]
    s_waitcnt vmcnt(0)
    v_mfma_f32_32x32x16_bf16 v[64:79], a[92:95], v[184:187], v[64:79]
    ds_read_b128 v[128:131], v48 offset:0
    ds_read_b128 v[132:135], v52 offset:0
    ds_read_b128 v[136:139], v49 offset:0
    ds_read_b128 v[140:143], v53 offset:0
    v_mfma_f32_32x32x16_bf16 v[80:95], a[92:95], v[188:191], v[80:95]
    ds_read_b128 v[144:147], v50 offset:0
    ds_read_b128 v[148:151], v54 offset:0
    ds_read_b128 v[152:155], v51 offset:0
    ds_read_b128 v[156:159], v55 offset:0
    v_mfma_f32_32x32x16_bf16 v[96:111], a[204:207], v[184:187], v[96:111]
    v_mfma_f32_32x32x16_bf16 v[112:127], a[204:207], v[188:191], v[112:127]
    s_waitcnt lgkmcnt(0)
    v_mfma_f32_32x32x16_bf16 v[112:127], a[208:211], v[132:135], v[112:127]
    v_mfma_f32_32x32x16_bf16 v[112:127], a[212:215], v[140:143], v[112:127]
    v_mfma_f32_32x32x16_bf16 v[112:127], a[216:219], v[148:151], v[112:127]
    v_mfma_f32_32x32x16_bf16 v[112:127], a[220:223], v[156:159], v[112:127]
    v_mfma_f32_32x32x16_bf16 v[96:111], a[208:211], v[128:131], v[96:111]
    v_mfma_f32_32x32x16_bf16 v[96:111], a[212:215], v[136:139], v[96:111]
    v_mfma_f32_32x32x16_bf16 v[96:111], a[216:219], v[144:147], v[96:111]
    v_mfma_f32_32x32x16_bf16 v[96:111], a[220:223], v[152:155], v[96:111]
    s_nop 7
    ds_write_b128 v45, v[112:115] offset:8192
    v_mfma_f32_32x32x16_bf16 v[80:95], a[96:99], v[132:135], v[80:95]
    ds_write_b128 v45, v[116:119] offset:9216
    v_mfma_f32_32x32x16_bf16 v[80:95], a[100:103], v[140:143], v[80:95]
    ds_write_b128 v45, v[120:123] offset:10240
    v_mfma_f32_32x32x16_bf16 v[80:95], a[104:107], v[148:151], v[80:95]
    ds_write_b128 v45, v[124:127] offset:11264
    v_mfma_f32_32x32x16_bf16 v[80:95], a[108:111], v[156:159], v[80:95]
    ds_write_b128 v45, v[96:99] offset:4096
    v_mfma_f32_32x32x16_bf16 v[64:79], a[96:99], v[128:131], v[64:79]
    ds_write_b128 v45, v[100:103] offset:5120
    v_mfma_f32_32x32x16_bf16 v[64:79], a[100:103], v[136:139], v[64:79]
    ds_write_b128 v45, v[104:107] offset:6144
    v_mfma_f32_32x32x16_bf16 v[64:79], a[104:107], v[144:147], v[64:79]
    ds_write_b128 v45, v[108:111] offset:7168
    v_mfma_f32_32x32x16_bf16 v[64:79], a[108:111], v[152:155], v[64:79]
    s_nop 3
    ds_write_b128 v45, v[80:83] offset:0
    ds_write_b128 v45, v[84:87] offset:1024
    ds_write_b128 v45, v[88:91] offset:2048
    ds_write_b128 v45, v[92:95] offset:3072
    s_waitcnt vmcnt(0) lgkmcnt(0)
    s_barrier
    ds_read_b64_tr_b16 v[24:25], v40 offset:0
    ds_read_b64_tr_b16 v[26:27], v40 offset:1024
    ds_read_b64_tr_b16 v[28:29], v40 offset:16384
    ds_read_b64_tr_b16 v[30:31], v40 offset:17408
    ds_read_b128 v[80:83], v57 offset:0
    ds_read_b128 v[84:87], v57 offset:1024
    ds_read_b128 v[88:91], v57 offset:2048
    ds_read_b128 v[92:95], v57 offset:3072
    ds_read_b128 v[96:99], v58 offset:4096
    ds_read_b128 v[100:103], v58 offset:5120
    ds_read_b128 v[104:107], v58 offset:6144
    ds_read_b128 v[108:111], v58 offset:7168
    ds_read_b128 v[112:115], v59 offset:8192
    ds_read_b128 v[116:119], v59 offset:9216
    ds_read_b128 v[120:123], v59 offset:10240
    ds_read_b128 v[124:127], v59 offset:11264
    s_waitcnt lgkmcnt(11)
    v_pk_add_f32 v[64:65], v[64:65], v[80:81]
    v_pk_add_f32 v[66:67], v[66:67], v[82:83]
    s_waitcnt lgkmcnt(10)
    v_pk_add_f32 v[68:69], v[68:69], v[84:85]
    v_pk_add_f32 v[70:71], v[70:71], v[86:87]
    s_waitcnt lgkmcnt(9)
    v_pk_add_f32 v[72:73], v[72:73], v[88:89]
    v_pk_add_f32 v[74:75], v[74:75], v[90:91]
    s_waitcnt lgkmcnt(8)
    v_pk_add_f32 v[76:77], v[76:77], v[92:93]
    v_pk_add_f32 v[78:79], v[78:79], v[94:95]
    s_waitcnt lgkmcnt(7)
    v_pk_add_f32 v[64:65], v[64:65], v[96:97]
    v_pk_add_f32 v[66:67], v[66:67], v[98:99]
    s_waitcnt lgkmcnt(6)
    v_pk_add_f32 v[68:69], v[68:69], v[100:101]
    v_pk_add_f32 v[70:71], v[70:71], v[102:103]
    s_waitcnt lgkmcnt(5)
    v_pk_add_f32 v[72:73], v[72:73], v[104:105]
    v_pk_add_f32 v[74:75], v[74:75], v[106:107]
    s_waitcnt lgkmcnt(4)
    v_pk_add_f32 v[76:77], v[76:77], v[108:109]
    v_pk_add_f32 v[78:79], v[78:79], v[110:111]
    s_waitcnt lgkmcnt(3)
    v_pk_add_f32 v[64:65], v[64:65], v[112:113]
    v_pk_add_f32 v[66:67], v[66:67], v[114:115]
    s_waitcnt lgkmcnt(2)
    v_pk_add_f32 v[68:69], v[68:69], v[116:117]
    v_pk_add_f32 v[70:71], v[70:71], v[118:119]
    s_waitcnt lgkmcnt(1)
    v_pk_add_f32 v[72:73], v[72:73], v[120:121]
    v_pk_add_f32 v[74:75], v[74:75], v[122:123]
    s_waitcnt lgkmcnt(0)
    v_pk_add_f32 v[76:77], v[76:77], v[124:125]
    v_pk_add_f32 v[78:79], v[78:79], v[126:127]
    s_mov_b32 s53, 0xffff0000
    v_lshlrev_b32 v33, 16, v24
    v_and_b32 v34, s53, v24
    v_add_f32 v64, v64, v33
    v_add_f32 v65, v65, v34
    v_cvt_pk_bf16_f32 v128, v64, v65
    v_lshlrev_b32 v33, 16, v25
    v_and_b32 v34, s53, v25
    v_add_f32 v66, v66, v33
    v_add_f32 v67, v67, v34
    v_cvt_pk_bf16_f32 v129, v66, v67
    v_lshlrev_b32 v33, 16, v26
    v_and_b32 v34, s53, v26
    v_add_f32 v68, v68, v33
    v_add_f32 v69, v69, v34
    v_cvt_pk_bf16_f32 v130, v68, v69
    v_lshlrev_b32 v33, 16, v27
    v_and_b32 v34, s53, v27
    v_add_f32 v70, v70, v33
    v_add_f32 v71, v71, v34
    v_cvt_pk_bf16_f32 v131, v70, v71
    v_lshlrev_b32 v33, 16, v28
    v_and_b32 v34, s53, v28
    v_add_f32 v72, v72, v33
    v_add_f32 v73, v73, v34
    v_cvt_pk_bf16_f32 v132, v72, v73
    v_lshlrev_b32 v33, 16, v29
    v_and_b32 v34, s53, v29
    v_add_f32 v74, v74, v33
    v_add_f32 v75, v75, v34
    v_cvt_pk_bf16_f32 v133, v74, v75
    v_lshlrev_b32 v33, 16, v30
    v_and_b32 v34, s53, v30
    v_add_f32 v76, v76, v33
    v_add_f32 v77, v77, v34
    v_cvt_pk_bf16_f32 v134, v76, v77
    v_lshlrev_b32 v33, 16, v31
    v_and_b32 v34, s53, v31
    v_add_f32 v78, v78, v33
    v_add_f32 v79, v79, v34
    v_cvt_pk_bf16_f32 v135, v78, v79
    v_permlane32_swap_b32 v128, v130
    v_permlane32_swap_b32 v129, v131
    buffer_store_dwordx4 v[128:131], v42, s[48:51], 0 offen offset:0
    v_permlane32_swap_b32 v132, v134
    v_permlane32_swap_b32 v133, v135
    buffer_store_dwordx4 v[132:135], v42, s[48:51], 0 offen offset:32
K_END:
    s_endpgm
K_CODE_END:
.section .rodata,"a"
.p2align 6
.amdhsa_kernel sequential_preLN__ssm_conv_s4__swiglu_ffn__prompt_kernel
  .amdhsa_next_free_vgpr 512
  .amdhsa_next_free_sgpr 102
  .amdhsa_accum_offset 256
  .amdhsa_group_segment_fixed_size 0
  .amdhsa_kernarg_size 128
  .amdhsa_user_sgpr_count 2
  .amdhsa_user_sgpr_kernarg_segment_ptr 1
  .amdhsa_system_sgpr_workgroup_id_x 1
  .amdhsa_float_denorm_mode_32 3
.end_amdhsa_kernel
```
